```python
import torch

def _softmax(x, axis=-1):
    return torch.softmax(x, dim=axis)
def _gelu(x):
    return torch.nn.functional.gelu(x, approximate="tanh")
def _silu(x):
    return torch.nn.functional.silu(x)
def _sigmoid(x):
    return torch.sigmoid(x)
def _layernorm(x, axis=-1, eps=1e-5):
    m = x.mean(dim=axis, keepdim=True)
    v = x.var(dim=axis, keepdim=True, unbiased=False)
    return (x - m) / torch.sqrt(v + eps)
def _scatter_add(tgt, idx, src, axis=0):
    return tgt.clone().index_add_(axis, idx, src)
def _segment_sum(src, seg, n):
    out = torch.zeros((n,) + src.shape[1:], dtype=src.dtype)
    return out.index_add_(0, seg, src)
def _pad(x, pw):
    flat = tuple(v for pair in reversed(pw) for v in pair)
    return torch.nn.functional.pad(x, flat)

kernel_name = 'gated_mix__ssm_conv_s5__mixer_channel_mlp__prompt'

def setup_inputs():

    _w = (lambda a: (lambda t: t.to(torch.bfloat16) if t.is_floating_point() else t)(torch.as_tensor(a)))
    def _A_setup():
        B, S, D = 1, 2048, 1024
        P = D
        Lambda_re = -0.5 * (lambda _x: torch.exp(torch.as_tensor(_x)))((lambda *s: torch.randn(*s, dtype=torch.bfloat16) * 0.4)(P))
        Lambda_im = (lambda *s: torch.randn(*s, dtype=torch.bfloat16) * 0.8)(P) * 1.0
        B_re = (lambda *s: torch.randn(*s, dtype=torch.bfloat16) * 0.8)(P, D) * (D ** -0.5)
        B_im = (lambda *s: torch.randn(*s, dtype=torch.bfloat16) * 0.4)(P, D) * (D ** -0.5)
        C_re = (lambda *s: torch.randn(*s, dtype=torch.bfloat16) * 0.8)(D, P) * (P ** -0.5)
        C_im = (lambda *s: torch.randn(*s, dtype=torch.bfloat16) * 0.8)(D, P) * (P ** -0.5)
        log_dt = (lambda *s: torch.randn(*s, dtype=torch.bfloat16) * 0.4)(P) * 0.3 - 2.0
        Dskip = (lambda *s: torch.randn(*s, dtype=torch.bfloat16) * 0.1)(D)
        return {
            "x": _w((lambda *s: torch.randn(*s, dtype=torch.bfloat16) * 0.05)(B, S, D)),
            "Lambda_re": _w(Lambda_re),
            "Lambda_im": _w(Lambda_im),
            "B_re": _w(B_re),
            "B_im": _w(B_im),
            "C_re": _w(C_re),
            "C_im": _w(C_im),
            "log_dt": _w(log_dt),
            "Dskip": _w(Dskip),
        }
    _A_in = _A_setup()

    def _B_setup():
        B, S, D, F = 1, 2048, 1024, 3584
        return {
            "x": _w((lambda *s: torch.randn(*s, dtype=torch.bfloat16) * 0.05)(B, S, D)),
            "w1": _w((lambda *s: torch.randn(*s, dtype=torch.bfloat16) * 0.8)(D, F) * (D ** -0.5)),
            "b1": _w((lambda *s: torch.randn(*s, dtype=torch.bfloat16) * 0.2)(F)),
            "w2": _w((lambda *s: torch.randn(*s, dtype=torch.bfloat16) * 0.05)(F, D) * (F ** -0.5)),
            "b2": _w((lambda *s: torch.randn(*s, dtype=torch.bfloat16) * 0.05)(D)),
        }
    _B_in = _B_setup()

    return {
        "A_x": _A_in["x"],
        "A_Lambda_re": _A_in["Lambda_re"],
        "A_Lambda_im": _A_in["Lambda_im"],
        "A_B_re": _A_in["B_re"],
        "A_B_im": _A_in["B_im"],
        "A_C_re": _A_in["C_re"],
        "A_C_im": _A_in["C_im"],
        "A_log_dt": _A_in["log_dt"],
        "A_Dskip": _A_in["Dskip"],
        "B_x": _B_in["x"],
        "B_w1": _B_in["w1"],
        "B_b1": _B_in["b1"],
        "B_w2": _B_in["w2"],
        "B_b2": _B_in["b2"],
        "gate_w": _w((lambda *s: torch.randn(*s, dtype=torch.bfloat16) * 0.05)(1024) * 16.0),
    }

def reference(A_x, A_Lambda_re, A_Lambda_im, A_B_re, A_B_im, A_C_re, A_C_im, A_log_dt, A_Dskip, B_x, B_w1, B_b1, B_w2, B_b2, gate_w):
    def _A_ref(x, Lambda_re, Lambda_im, B_re, B_im, C_re, C_im, log_dt, Dskip):
        Bsz, L, H = x.shape
        Lam = Lambda_re + 1j * Lambda_im
        Bmat = B_re + 1j * B_im
        Cmat = C_re + 1j * C_im
        dt = torch.exp(log_dt)
        Lam_bar = torch.exp(dt * Lam)
        B_bar = ((Lam_bar - 1.0) / Lam)[:, None] * Bmat
        Bu = torch.einsum("bld,pd->blp", x + 0j, B_bar)
        h = torch.zeros_like(Bu[:, 0, :])
        hs = []
        for t in range(L):
            h = Lam_bar[None, :] * h + Bu[:, t, :]
            hs.append(h)
        hseq = torch.stack(hs, 1)
        y = 2.0 * torch.einsum("blp,dp->bld", hseq, Cmat).real + x * Dskip[None, None, :]
        return y

    def _B_ref(x, w1, b1, w2, b2):
        y = _layernorm(x, axis=-1)
        h = _gelu(torch.einsum("bsd,df->bsf", y, w1) + b1)
        return torch.einsum("bsf,fd->bsd", h, w2) + b2

    x = A_x
    g = _sigmoid((x * gate_w).sum(-1, keepdims=True))
    a = _A_ref(x, A_Lambda_re, A_Lambda_im, A_B_re, A_B_im, A_C_re, A_C_im, A_log_dt, A_Dskip)
    b = _B_ref(x, B_w1, B_b1, B_w2, B_b2)
    return g * a + (1 - g) * b
```

```asm
; @launch kernel=k1_kernel grid=(256,1,1) block=(512,1,1) lds=163840
.amdgcn_target "amdgcn-amd-amdhsa--gfx950"
.text
    .globl k1_kernel
    .p2align 8
    .type k1_kernel,@function
k1_kernel:
    s_cmp_ge_u32 s2, 256
    s_cbranch_scc1 L_k1_kernel_end
    s_load_dwordx8 s[4:11], s[0:1], 0
    s_load_dwordx8 s[12:19], s[0:1], 32
    s_load_dwordx8 s[20:27], s[0:1], 80
    s_load_dwordx2 s[28:29], s[0:1], 112
    s_load_dwordx4 s[32:35], s[0:1], 128
    v_and_b32 v1, 63, v0
    v_lshrrev_b32 v2, 6, v0
    s_nop 0
    v_readfirstlane_b32 s68, v2
    s_and_b32 s71, s2, 7
    s_lshr_b32 s72, s2, 3
    s_and_b32 s69, s71, 1
    s_lshl_b32 s69, s69, 2
    s_and_b32 s73, s72, 3
    s_add_u32 s69, s69, s73
    s_lshr_b32 s70, s71, 1
    s_lshl_b32 s70, s70, 3
    s_lshr_b32 s73, s72, 2
    s_add_u32 s70, s70, s73
    s_and_b32 s76, s70, 1
    v_and_b32 v2, 15, v1
    v_lshrrev_b32 v3, 4, v1
    s_cmp_ge_u32 s68, 4
    s_cbranch_scc1 L_k1_kernel_loader
    v_and_b32 v19, 7, v2
    v_xor_b32 v20, v3, v19
    v_lshlrev_b32 v20, 4, v20
    v_lshlrev_b32 v21, 7, v2
    v_add_u32 v20, v20, v21
    v_add_u32 v6, 0x8000, v20
    v_xor_b32 v7, 64, v6
    s_lshl_b32 s71, s68, 13
    v_add_u32 v4, s71, v20
    v_xor_b32 v5, 64, v4
    v_lshrrev_b32 v19, 2, v1
    v_mul_u32_u24 v19, 224, v19
    v_and_b32 v20, 3, v1
    v_lshlrev_b32 v20, 3, v20
    v_add_u32 v19, v19, v20
    v_add_u32 v19, 122880, v19
    s_lshl_b32 s71, s76, 5
    v_add_u32 v8, s71, v19
    s_cmp_eq_u32 s76, 0
    s_cselect_b32 s71, 192, 0
    v_add_u32 v9, s71, v19
    s_getpc_b64 s[86:87]
L_k1_kernel_pc:
    s_sub_u32 s86, s86, L_k1_kernel_pc-k1_kernel
    s_subb_u32 s87, s87, 0
    s_lshr_b32 s71, s2, 3
    s_lshl_b32 s71, s71, 2
    s_add_u32 s71, s71, s68
    s_mul_i32 s71, s71, 320
    s_min_u32 s71, s71, L_code_end-k1_kernel-320
    s_add_u32 s86, s86, s71
    s_addc_u32 s87, s87, 0
    s_load_dword s3, s[86:87], 0
    s_load_dword s3, s[86:87], 64
    s_load_dword s3, s[86:87], 128
    s_load_dword s3, s[86:87], 192
    s_load_dword s3, s[86:87], 256
    v_mov_b32 v80, 0
    v_mov_b32 v81, 0
    v_mov_b32 v82, 0
    v_mov_b32 v83, 0
    v_mov_b32 v84, 0
    v_mov_b32 v85, 0
    v_mov_b32 v86, 0
    v_mov_b32 v87, 0
    v_mov_b32 v88, 0
    v_mov_b32 v89, 0
    v_mov_b32 v90, 0
    v_mov_b32 v91, 0
    v_mov_b32 v92, 0
    v_mov_b32 v93, 0
    v_mov_b32 v94, 0
    v_mov_b32 v95, 0
    v_mov_b32 v96, 0
    v_mov_b32 v97, 0
    v_mov_b32 v98, 0
    v_mov_b32 v99, 0
    v_mov_b32 v100, 0
    v_mov_b32 v101, 0
    v_mov_b32 v102, 0
    v_mov_b32 v103, 0
    v_mov_b32 v104, 0
    v_mov_b32 v105, 0
    v_mov_b32 v106, 0
    v_mov_b32 v107, 0
    v_mov_b32 v108, 0
    v_mov_b32 v109, 0
    v_mov_b32 v110, 0
    v_mov_b32 v111, 0
    v_mov_b32 v112, 0
    v_mov_b32 v113, 0
    v_mov_b32 v114, 0
    v_mov_b32 v115, 0
    v_mov_b32 v116, 0
    v_mov_b32 v117, 0
    v_mov_b32 v118, 0
    v_mov_b32 v119, 0
    v_mov_b32 v120, 0
    v_mov_b32 v121, 0
    v_mov_b32 v122, 0
    v_mov_b32 v123, 0
    v_mov_b32 v124, 0
    v_mov_b32 v125, 0
    v_mov_b32 v126, 0
    v_mov_b32 v127, 0
    v_mov_b32 v128, 0
    v_mov_b32 v129, 0
    v_mov_b32 v130, 0
    v_mov_b32 v131, 0
    v_mov_b32 v132, 0
    v_mov_b32 v133, 0
    v_mov_b32 v134, 0
    v_mov_b32 v135, 0
    v_mov_b32 v136, 0
    v_mov_b32 v137, 0
    v_mov_b32 v138, 0
    v_mov_b32 v139, 0
    v_mov_b32 v140, 0
    v_mov_b32 v141, 0
    v_mov_b32 v142, 0
    v_mov_b32 v143, 0
    v_mov_b32 v144, 0
    v_mov_b32 v145, 0
    v_mov_b32 v146, 0
    v_mov_b32 v147, 0
    v_mov_b32 v148, 0
    v_mov_b32 v149, 0
    v_mov_b32 v150, 0
    v_mov_b32 v151, 0
    v_mov_b32 v152, 0
    v_mov_b32 v153, 0
    v_mov_b32 v154, 0
    v_mov_b32 v155, 0
    v_mov_b32 v156, 0
    v_mov_b32 v157, 0
    v_mov_b32 v158, 0
    v_mov_b32 v159, 0
    v_mov_b32 v160, 0
    v_mov_b32 v161, 0
    v_mov_b32 v162, 0
    v_mov_b32 v163, 0
    v_mov_b32 v164, 0
    v_mov_b32 v165, 0
    v_mov_b32 v166, 0
    v_mov_b32 v167, 0
    v_mov_b32 v168, 0
    v_mov_b32 v169, 0
    v_mov_b32 v170, 0
    v_mov_b32 v171, 0
    v_mov_b32 v172, 0
    v_mov_b32 v173, 0
    v_mov_b32 v174, 0
    v_mov_b32 v175, 0
    v_mov_b32 v176, 0
    v_mov_b32 v177, 0
    v_mov_b32 v178, 0
    v_mov_b32 v179, 0
    v_mov_b32 v180, 0
    v_mov_b32 v181, 0
    v_mov_b32 v182, 0
    v_mov_b32 v183, 0
    v_mov_b32 v184, 0
    v_mov_b32 v185, 0
    v_mov_b32 v186, 0
    v_mov_b32 v187, 0
    v_mov_b32 v188, 0
    v_mov_b32 v189, 0
    v_mov_b32 v190, 0
    v_mov_b32 v191, 0
    v_mov_b32 v192, 0
    v_mov_b32 v193, 0
    v_mov_b32 v194, 0
    v_mov_b32 v195, 0
    v_mov_b32 v196, 0
    v_mov_b32 v197, 0
    v_mov_b32 v198, 0
    v_mov_b32 v199, 0
    v_mov_b32 v200, 0
    v_mov_b32 v201, 0
    v_mov_b32 v202, 0
    v_mov_b32 v203, 0
    v_mov_b32 v204, 0
    v_mov_b32 v205, 0
    v_mov_b32 v206, 0
    v_mov_b32 v207, 0
    v_mov_b32 v208, 0
    v_mov_b32 v209, 0
    v_mov_b32 v210, 0
    v_mov_b32 v211, 0
    v_mov_b32 v212, 0
    v_mov_b32 v213, 0
    v_mov_b32 v214, 0
    v_mov_b32 v215, 0
    v_mov_b32 v216, 0
    v_mov_b32 v217, 0
    v_mov_b32 v218, 0
    v_mov_b32 v219, 0
    v_mov_b32 v220, 0
    v_mov_b32 v221, 0
    v_mov_b32 v222, 0
    v_mov_b32 v223, 0
    v_mov_b32 v224, 0
    v_mov_b32 v225, 0
    v_mov_b32 v226, 0
    v_mov_b32 v227, 0
    v_mov_b32 v228, 0
    v_mov_b32 v229, 0
    v_mov_b32 v230, 0
    v_mov_b32 v231, 0
    v_mov_b32 v232, 0
    v_mov_b32 v233, 0
    v_mov_b32 v234, 0
    v_mov_b32 v235, 0
    v_mov_b32 v236, 0
    v_mov_b32 v237, 0
    v_mov_b32 v238, 0
    v_mov_b32 v239, 0
    v_mov_b32 v240, 0
    v_mov_b32 v241, 0
    v_mov_b32 v242, 0
    v_mov_b32 v243, 0
    v_mov_b32 v244, 0
    v_mov_b32 v245, 0
    v_mov_b32 v246, 0
    v_mov_b32 v247, 0
    v_mov_b32 v248, 0
    v_mov_b32 v249, 0
    v_mov_b32 v250, 0
    v_mov_b32 v251, 0
    v_mov_b32 v252, 0
    v_mov_b32 v253, 0
    v_mov_b32 v254, 0
    v_mov_b32 v255, 0
    s_mov_b32 s77, 0
    s_mov_b32 s78, 0
    s_mov_b32 s98, 40960
    s_mov_b32 s99, 7168
    s_waitcnt lgkmcnt(0)
    s_mov_b32 s48, s34
    s_and_b32 s49, s35, 0xffff
    s_mov_b32 s50, 50331648
    s_mov_b32 s51, 0x20000
    s_mov_b32 s52, s32
    s_and_b32 s53, s33, 0xffff
    s_mov_b32 s54, 256
    s_mov_b32 s55, 0x20000
    s_lshl_b32 s71, s2, 2
    s_add_u32 s71, s71, s68
    s_mul_i32 s88, s71, 7168
    s_and_b32 s89, s71, 511
    s_lshl_b32 s89, s89, 12
    v_lshlrev_b32 v20, 7, v1
    s_sub_u32 s88, s88, 2560
    s_sub_u32 s89, s89, 1536
    s_cmp_lt_u32 s71, 512
    s_cselect_b32 s84, s14, s16
    s_cselect_b32 s85, s15, s17
    s_mov_b32 s56, s24
    s_and_b32 s57, s25, 0xffff
    s_mov_b32 s58, 0
    s_mov_b32 s59, 0x20000
    s_mov_b32 s60, s84
    s_and_b32 s61, s85, 0xffff
    s_mov_b32 s62, 0
    s_mov_b32 s63, 0x20000
    s_lshl_b32 s74, s69, 5
    s_add_u32 s74, s74, s70
    s_lshr_b32 s81, s2, 3
    s_and_b32 s81, s81, 0
    s_sub_u32 s81, 5, s81
    s_cmp_eq_u32 s68, 0
    s_cselect_b32 s81, s81, 99
    v_mov_b32 v18, 0
    v_mov_b32 v19, 1
    s_lshl_b32 s88, s69, 19
    s_lshr_b32 s71, s68, 1
    s_lshl_b32 s71, s71, 18
    s_add_u32 s88, s88, s71
    s_lshl_b32 s71, s70, 13
    s_add_u32 s88, s88, s71
    s_and_b32 s71, s68, 1
    s_lshl_b32 s71, s71, 12
    s_add_u32 s88, s88, s71
    s_add_u32 s88, s88, 37748736
    v_mov_b32 v12, -1
    v_mov_b32 v13, -1
    v_mov_b32 v14, -1
    v_mov_b32 v15, -1
    v_lshlrev_b32 v10, 3, v1
    s_barrier
    ds_read_b128 v[32:35], v4 offset:0
    ds_read_b128 v[36:39], v4 offset:2048
    ds_read_b128 v[40:43], v4 offset:4096
    ds_read_b128 v[44:47], v4 offset:6144
    ds_read_b128 v[64:67], v6 offset:0
    ds_read_b128 v[68:71], v6 offset:2048
    ds_read_b128 v[72:75], v6 offset:4096
    s_waitcnt lgkmcnt(3)
    s_mov_b32 s75, 8
    s_mov_b32 m0, 0
L_k1_kernel_loop:
    s_waitcnt lgkmcnt(2)
    v_mfma_f32_16x16x32_bf16 v[80:83], v[32:35], v[64:67], v[80:83]
    ds_read_b128 v[76:79], v6 offset:6144
    v_mfma_f32_16x16x32_bf16 v[84:87], v[36:39], v[64:67], v[84:87]
    v_mfma_f32_16x16x32_bf16 v[88:91], v[40:43], v[64:67], v[88:91]
    v_mfma_f32_16x16x32_bf16 v[92:95], v[44:47], v[64:67], v[92:95]
    s_waitcnt lgkmcnt(2)
    v_mfma_f32_16x16x32_bf16 v[96:99], v[32:35], v[68:71], v[96:99]
    ds_read_b64_tr_b16 v[64:65], v8 offset:0
    ds_read_b64_tr_b16 v[66:67], v8 offset:3584
    v_mfma_f32_16x16x32_bf16 v[100:103], v[36:39], v[68:71], v[100:103]
    v_mfma_f32_16x16x32_bf16 v[104:107], v[40:43], v[68:71], v[104:107]
    v_mfma_f32_16x16x32_bf16 v[108:111], v[44:47], v[68:71], v[108:111]
    s_waitcnt lgkmcnt(3)
    v_mfma_f32_16x16x32_bf16 v[112:115], v[32:35], v[72:75], v[112:115]
    ds_read_b64_tr_b16 v[68:69], v8 offset:32
    ds_read_b64_tr_b16 v[70:71], v8 offset:3616
    v_mfma_f32_16x16x32_bf16 v[116:119], v[36:39], v[72:75], v[116:119]
    ds_read_b128 v[48:51], v5 offset:0
    v_mfma_f32_16x16x32_bf16 v[120:123], v[40:43], v[72:75], v[120:123]
    v_mfma_f32_16x16x32_bf16 v[124:127], v[44:47], v[72:75], v[124:127]
    s_waitcnt lgkmcnt(5)
    v_mfma_f32_16x16x32_bf16 v[128:131], v[32:35], v[76:79], v[128:131]
    ds_read_b64_tr_b16 v[72:73], v8 offset:64
    ds_read_b64_tr_b16 v[74:75], v8 offset:3648
    v_mfma_f32_16x16x32_bf16 v[132:135], v[36:39], v[76:79], v[132:135]
    ds_read_b128 v[52:55], v5 offset:2048
    v_mfma_f32_16x16x32_bf16 v[136:139], v[40:43], v[76:79], v[136:139]
    v_mfma_f32_16x16x32_bf16 v[140:143], v[44:47], v[76:79], v[140:143]
    s_waitcnt lgkmcnt(6)
    v_mfma_f32_16x16x32_bf16 v[144:147], v[64:67], v[32:35], v[144:147]
    ds_read_b64_tr_b16 v[76:77], v8 offset:96
    ds_read_b64_tr_b16 v[78:79], v8 offset:3680
    v_mfma_f32_16x16x32_bf16 v[148:151], v[64:67], v[36:39], v[148:151]
    ds_read_b128 v[56:59], v5 offset:4096
    v_mfma_f32_16x16x32_bf16 v[152:155], v[64:67], v[40:43], v[152:155]
    v_mfma_f32_16x16x32_bf16 v[156:159], v[64:67], v[44:47], v[156:159]
    s_waitcnt lgkmcnt(7)
    v_mfma_f32_16x16x32_bf16 v[160:163], v[68:71], v[32:35], v[160:163]
    ds_read_b64_tr_b16 v[64:65], v8 offset:128
    ds_read_b64_tr_b16 v[66:67], v8 offset:3712
    v_mfma_f32_16x16x32_bf16 v[164:167], v[68:71], v[36:39], v[164:167]
    ds_read_b128 v[60:63], v5 offset:6144
    v_mfma_f32_16x16x32_bf16 v[168:171], v[68:71], v[40:43], v[168:171]
    v_mfma_f32_16x16x32_bf16 v[172:175], v[68:71], v[44:47], v[172:175]
    s_waitcnt lgkmcnt(7)
    v_mfma_f32_16x16x32_bf16 v[176:179], v[72:75], v[32:35], v[176:179]
    ds_read_b64_tr_b16 v[68:69], v8 offset:160
    ds_read_b64_tr_b16 v[70:71], v8 offset:3744
    v_mfma_f32_16x16x32_bf16 v[180:183], v[72:75], v[36:39], v[180:183]
    v_mfma_f32_16x16x32_bf16 v[184:187], v[72:75], v[40:43], v[184:187]
    v_mfma_f32_16x16x32_bf16 v[188:191], v[72:75], v[44:47], v[188:191]
    s_waitcnt lgkmcnt(6)
    v_mfma_f32_16x16x32_bf16 v[192:195], v[76:79], v[32:35], v[192:195]
    ds_read_b64_tr_b16 v[72:73], v9 offset:0
    ds_read_b64_tr_b16 v[74:75], v9 offset:3584
    v_mfma_f32_16x16x32_bf16 v[196:199], v[76:79], v[36:39], v[196:199]
    v_mfma_f32_16x16x32_bf16 v[200:203], v[76:79], v[40:43], v[200:203]
    v_mfma_f32_16x16x32_bf16 v[204:207], v[76:79], v[44:47], v[204:207]
    s_waitcnt lgkmcnt(5)
    v_mfma_f32_16x16x32_bf16 v[208:211], v[64:67], v[32:35], v[208:211]
    ds_read_b128 v[76:79], v7 offset:0
    s_add_u32 s78, s78, 7168
    v_mfma_f32_16x16x32_bf16 v[212:215], v[64:67], v[36:39], v[212:215]
    s_cmp_eq_u32 s78, 35840
    s_cselect_b32 s80, 4294938624, s99
    v_mfma_f32_16x16x32_bf16 v[216:219], v[64:67], v[40:43], v[216:219]
    s_cselect_b32 s78, 0, s78
    v_add_u32 v8, s80, v8
    v_mfma_f32_16x16x32_bf16 v[220:223], v[64:67], v[44:47], v[220:223]
    v_add_u32 v9, s80, v9
    s_waitcnt lgkmcnt(3)
    v_mfma_f32_16x16x32_bf16 v[224:227], v[68:71], v[32:35], v[224:227]
    ds_read_b128 v[64:67], v7 offset:2048
    v_mfma_f32_16x16x32_bf16 v[228:231], v[68:71], v[36:39], v[228:231]
    v_mfma_f32_16x16x32_bf16 v[232:235], v[68:71], v[40:43], v[232:235]
    v_mfma_f32_16x16x32_bf16 v[236:239], v[68:71], v[44:47], v[236:239]
    s_waitcnt lgkmcnt(2)
    v_mfma_f32_16x16x32_bf16 v[240:243], v[72:75], v[32:35], v[240:243]
    ds_read_b128 v[68:71], v7 offset:4096
    v_mfma_f32_16x16x32_bf16 v[244:247], v[72:75], v[36:39], v[244:247]
    v_mfma_f32_16x16x32_bf16 v[248:251], v[72:75], v[40:43], v[248:251]
    v_mfma_f32_16x16x32_bf16 v[252:255], v[72:75], v[44:47], v[252:255]
    s_barrier
    s_waitcnt lgkmcnt(2)
    v_mfma_f32_16x16x32_bf16 v[80:83], v[48:51], v[76:79], v[80:83]
    ds_read_b128 v[72:75], v7 offset:6144
    s_add_u32 s77, s77, 40960
    v_mfma_f32_16x16x32_bf16 v[84:87], v[52:55], v[76:79], v[84:87]
    s_cmp_eq_u32 s77, 122880
    s_cselect_b32 s79, 4294885376, s98
    v_mfma_f32_16x16x32_bf16 v[88:91], v[56:59], v[76:79], v[88:91]
    s_cselect_b32 s77, 0, s77
    v_add_u32 v4, s79, v4
    v_mfma_f32_16x16x32_bf16 v[92:95], v[60:63], v[76:79], v[92:95]
    v_add_u32 v6, s79, v6
    s_waitcnt lgkmcnt(2)
    v_mfma_f32_16x16x32_bf16 v[96:99], v[48:51], v[64:67], v[96:99]
    ds_read_b64_tr_b16 v[76:77], v8 offset:0
    ds_read_b64_tr_b16 v[78:79], v8 offset:3584
    v_mfma_f32_16x16x32_bf16 v[100:103], v[52:55], v[64:67], v[100:103]
    v_add_u32 v5, s79, v5
    v_add_u32 v7, s79, v7
    v_mfma_f32_16x16x32_bf16 v[104:107], v[56:59], v[64:67], v[104:107]
    v_mfma_f32_16x16x32_bf16 v[108:111], v[60:63], v[64:67], v[108:111]
    s_waitcnt lgkmcnt(3)
    v_mfma_f32_16x16x32_bf16 v[112:115], v[48:51], v[68:71], v[112:115]
    ds_read_b64_tr_b16 v[64:65], v8 offset:32
    ds_read_b64_tr_b16 v[66:67], v8 offset:3616
    v_mfma_f32_16x16x32_bf16 v[116:119], v[52:55], v[68:71], v[116:119]
    ds_read_b128 v[32:35], v4 offset:0
    v_mfma_f32_16x16x32_bf16 v[120:123], v[56:59], v[68:71], v[120:123]
    v_mfma_f32_16x16x32_bf16 v[124:127], v[60:63], v[68:71], v[124:127]
    s_waitcnt lgkmcnt(5)
    v_mfma_f32_16x16x32_bf16 v[128:131], v[48:51], v[72:75], v[128:131]
    ds_read_b64_tr_b16 v[68:69], v8 offset:64
    ds_read_b64_tr_b16 v[70:71], v8 offset:3648
    v_mfma_f32_16x16x32_bf16 v[132:135], v[52:55], v[72:75], v[132:135]
    ds_read_b128 v[36:39], v4 offset:2048
    v_mfma_f32_16x16x32_bf16 v[136:139], v[56:59], v[72:75], v[136:139]
    v_mfma_f32_16x16x32_bf16 v[140:143], v[60:63], v[72:75], v[140:143]
    s_waitcnt lgkmcnt(6)
    v_mfma_f32_16x16x32_bf16 v[144:147], v[76:79], v[48:51], v[144:147]
    ds_read_b64_tr_b16 v[72:73], v8 offset:96
    ds_read_b64_tr_b16 v[74:75], v8 offset:3680
    v_mfma_f32_16x16x32_bf16 v[148:151], v[76:79], v[52:55], v[148:151]
    ds_read_b128 v[40:43], v4 offset:4096
    v_mfma_f32_16x16x32_bf16 v[152:155], v[76:79], v[56:59], v[152:155]
    v_mfma_f32_16x16x32_bf16 v[156:159], v[76:79], v[60:63], v[156:159]
    s_waitcnt lgkmcnt(7)
    v_mfma_f32_16x16x32_bf16 v[160:163], v[64:67], v[48:51], v[160:163]
    ds_read_b64_tr_b16 v[76:77], v8 offset:128
    ds_read_b64_tr_b16 v[78:79], v8 offset:3712
    v_mfma_f32_16x16x32_bf16 v[164:167], v[64:67], v[52:55], v[164:167]
    ds_read_b128 v[44:47], v4 offset:6144
    v_mfma_f32_16x16x32_bf16 v[168:171], v[64:67], v[56:59], v[168:171]
    v_mfma_f32_16x16x32_bf16 v[172:175], v[64:67], v[60:63], v[172:175]
    s_waitcnt lgkmcnt(7)
    v_mfma_f32_16x16x32_bf16 v[176:179], v[68:71], v[48:51], v[176:179]
    ds_read_b64_tr_b16 v[64:65], v8 offset:160
    ds_read_b64_tr_b16 v[66:67], v8 offset:3744
    v_mfma_f32_16x16x32_bf16 v[180:183], v[68:71], v[52:55], v[180:183]
    v_mfma_f32_16x16x32_bf16 v[184:187], v[68:71], v[56:59], v[184:187]
    v_mfma_f32_16x16x32_bf16 v[188:191], v[68:71], v[60:63], v[188:191]
    s_waitcnt lgkmcnt(6)
    v_mfma_f32_16x16x32_bf16 v[192:195], v[72:75], v[48:51], v[192:195]
    ds_read_b64_tr_b16 v[68:69], v9 offset:0
    ds_read_b64_tr_b16 v[70:71], v9 offset:3584
    v_mfma_f32_16x16x32_bf16 v[196:199], v[72:75], v[52:55], v[196:199]
    v_mfma_f32_16x16x32_bf16 v[200:203], v[72:75], v[56:59], v[200:203]
    v_mfma_f32_16x16x32_bf16 v[204:207], v[72:75], v[60:63], v[204:207]
    s_waitcnt lgkmcnt(5)
    v_mfma_f32_16x16x32_bf16 v[208:211], v[76:79], v[48:51], v[208:211]
    ds_read_b128 v[72:75], v6 offset:0
    s_add_u32 s78, s78, 7168
    v_mfma_f32_16x16x32_bf16 v[212:215], v[76:79], v[52:55], v[212:215]
    s_cmp_eq_u32 s78, 35840
    s_cselect_b32 s80, 4294938624, s99
    v_mfma_f32_16x16x32_bf16 v[216:219], v[76:79], v[56:59], v[216:219]
    s_cselect_b32 s78, 0, s78
    v_add_u32 v8, s80, v8
    v_mfma_f32_16x16x32_bf16 v[220:223], v[76:79], v[60:63], v[220:223]
    v_add_u32 v9, s80, v9
    s_waitcnt lgkmcnt(3)
    v_mfma_f32_16x16x32_bf16 v[224:227], v[64:67], v[48:51], v[224:227]
    ds_read_b128 v[76:79], v6 offset:2048
    buffer_store_dwordx2 v[12:13], v10, s[48:51], s88 offen sc0 sc1
    v_mfma_f32_16x16x32_bf16 v[228:231], v[64:67], v[52:55], v[228:231]
    s_add_u32 s88, s88, 512
    v_mfma_f32_16x16x32_bf16 v[232:235], v[64:67], v[56:59], v[232:235]
    v_mfma_f32_16x16x32_bf16 v[236:239], v[64:67], v[60:63], v[236:239]
    s_waitcnt lgkmcnt(2)
    v_mfma_f32_16x16x32_bf16 v[240:243], v[68:71], v[48:51], v[240:243]
    ds_read_b128 v[64:67], v6 offset:4096
    v_mfma_f32_16x16x32_bf16 v[244:247], v[68:71], v[52:55], v[244:247]
    v_mfma_f32_16x16x32_bf16 v[248:251], v[68:71], v[56:59], v[248:251]
    v_mfma_f32_16x16x32_bf16 v[252:255], v[68:71], v[60:63], v[252:255]
    s_barrier
    s_waitcnt lgkmcnt(2)
    v_mfma_f32_16x16x32_bf16 v[80:83], v[32:35], v[72:75], v[80:83]
    ds_read_b128 v[68:71], v6 offset:6144
    v_mfma_f32_16x16x32_bf16 v[84:87], v[36:39], v[72:75], v[84:87]
    v_mfma_f32_16x16x32_bf16 v[88:91], v[40:43], v[72:75], v[88:91]
    v_mfma_f32_16x16x32_bf16 v[92:95], v[44:47], v[72:75], v[92:95]
    s_waitcnt lgkmcnt(2)
    v_mfma_f32_16x16x32_bf16 v[96:99], v[32:35], v[76:79], v[96:99]
    ds_read_b64_tr_b16 v[72:73], v8 offset:0
    ds_read_b64_tr_b16 v[74:75], v8 offset:3584
    v_mfma_f32_16x16x32_bf16 v[100:103], v[36:39], v[76:79], v[100:103]
    v_mfma_f32_16x16x32_bf16 v[104:107], v[40:43], v[76:79], v[104:107]
    v_mfma_f32_16x16x32_bf16 v[108:111], v[44:47], v[76:79], v[108:111]
    s_waitcnt lgkmcnt(3)
    v_mfma_f32_16x16x32_bf16 v[112:115], v[32:35], v[64:67], v[112:115]
    ds_read_b64_tr_b16 v[76:77], v8 offset:32
    ds_read_b64_tr_b16 v[78:79], v8 offset:3616
    v_mfma_f32_16x16x32_bf16 v[116:119], v[36:39], v[64:67], v[116:119]
    ds_read_b128 v[48:51], v5 offset:0
    v_mfma_f32_16x16x32_bf16 v[120:123], v[40:43], v[64:67], v[120:123]
    v_mfma_f32_16x16x32_bf16 v[124:127], v[44:47], v[64:67], v[124:127]
    s_waitcnt lgkmcnt(5)
    v_mfma_f32_16x16x32_bf16 v[128:131], v[32:35], v[68:71], v[128:131]
    ds_read_b64_tr_b16 v[64:65], v8 offset:64
    ds_read_b64_tr_b16 v[66:67], v8 offset:3648
    v_mfma_f32_16x16x32_bf16 v[132:135], v[36:39], v[68:71], v[132:135]
    ds_read_b128 v[52:55], v5 offset:2048
    v_mfma_f32_16x16x32_bf16 v[136:139], v[40:43], v[68:71], v[136:139]
    v_mfma_f32_16x16x32_bf16 v[140:143], v[44:47], v[68:71], v[140:143]
    s_waitcnt lgkmcnt(6)
    v_mfma_f32_16x16x32_bf16 v[144:147], v[72:75], v[32:35], v[144:147]
    ds_read_b64_tr_b16 v[68:69], v8 offset:96
    ds_read_b64_tr_b16 v[70:71], v8 offset:3680
    v_mfma_f32_16x16x32_bf16 v[148:151], v[72:75], v[36:39], v[148:151]
    ds_read_b128 v[56:59], v5 offset:4096
    v_mfma_f32_16x16x32_bf16 v[152:155], v[72:75], v[40:43], v[152:155]
    v_mfma_f32_16x16x32_bf16 v[156:159], v[72:75], v[44:47], v[156:159]
    s_waitcnt lgkmcnt(7)
    v_mfma_f32_16x16x32_bf16 v[160:163], v[76:79], v[32:35], v[160:163]
    ds_read_b64_tr_b16 v[72:73], v8 offset:128
    ds_read_b64_tr_b16 v[74:75], v8 offset:3712
    v_mfma_f32_16x16x32_bf16 v[164:167], v[76:79], v[36:39], v[164:167]
    ds_read_b128 v[60:63], v5 offset:6144
    v_mfma_f32_16x16x32_bf16 v[168:171], v[76:79], v[40:43], v[168:171]
    v_mfma_f32_16x16x32_bf16 v[172:175], v[76:79], v[44:47], v[172:175]
    s_waitcnt lgkmcnt(7)
    v_mfma_f32_16x16x32_bf16 v[176:179], v[64:67], v[32:35], v[176:179]
    ds_read_b64_tr_b16 v[76:77], v8 offset:160
    ds_read_b64_tr_b16 v[78:79], v8 offset:3744
    v_mfma_f32_16x16x32_bf16 v[180:183], v[64:67], v[36:39], v[180:183]
    v_mfma_f32_16x16x32_bf16 v[184:187], v[64:67], v[40:43], v[184:187]
    v_mfma_f32_16x16x32_bf16 v[188:191], v[64:67], v[44:47], v[188:191]
    s_waitcnt lgkmcnt(6)
    v_mfma_f32_16x16x32_bf16 v[192:195], v[68:71], v[32:35], v[192:195]
    ds_read_b64_tr_b16 v[64:65], v9 offset:0
    ds_read_b64_tr_b16 v[66:67], v9 offset:3584
    v_mfma_f32_16x16x32_bf16 v[196:199], v[68:71], v[36:39], v[196:199]
    v_mfma_f32_16x16x32_bf16 v[200:203], v[68:71], v[40:43], v[200:203]
    v_mfma_f32_16x16x32_bf16 v[204:207], v[68:71], v[44:47], v[204:207]
    s_waitcnt lgkmcnt(5)
    v_mfma_f32_16x16x32_bf16 v[208:211], v[72:75], v[32:35], v[208:211]
    ds_read_b128 v[68:71], v7 offset:0
    s_add_u32 s78, s78, 7168
    v_mfma_f32_16x16x32_bf16 v[212:215], v[72:75], v[36:39], v[212:215]
    s_cmp_eq_u32 s78, 35840
    s_cselect_b32 s80, 4294938624, s99
    v_mfma_f32_16x16x32_bf16 v[216:219], v[72:75], v[40:43], v[216:219]
    s_cselect_b32 s78, 0, s78
    v_add_u32 v8, s80, v8
    v_mfma_f32_16x16x32_bf16 v[220:223], v[72:75], v[44:47], v[220:223]
    v_add_u32 v9, s80, v9
    s_waitcnt lgkmcnt(3)
    v_mfma_f32_16x16x32_bf16 v[224:227], v[76:79], v[32:35], v[224:227]
    ds_read_b128 v[72:75], v7 offset:2048
    v_mfma_f32_16x16x32_bf16 v[228:231], v[76:79], v[36:39], v[228:231]
    v_mfma_f32_16x16x32_bf16 v[232:235], v[76:79], v[40:43], v[232:235]
    v_mfma_f32_16x16x32_bf16 v[236:239], v[76:79], v[44:47], v[236:239]
    s_waitcnt lgkmcnt(2)
    v_mfma_f32_16x16x32_bf16 v[240:243], v[64:67], v[32:35], v[240:243]
    ds_read_b128 v[76:79], v7 offset:4096
    v_mfma_f32_16x16x32_bf16 v[244:247], v[64:67], v[36:39], v[244:247]
    v_mfma_f32_16x16x32_bf16 v[248:251], v[64:67], v[40:43], v[248:251]
    v_mfma_f32_16x16x32_bf16 v[252:255], v[64:67], v[44:47], v[252:255]
    s_barrier
    s_waitcnt lgkmcnt(2)
    v_mfma_f32_16x16x32_bf16 v[80:83], v[48:51], v[68:71], v[80:83]
    ds_read_b128 v[64:67], v7 offset:6144
    s_add_u32 s77, s77, 40960
    v_mfma_f32_16x16x32_bf16 v[84:87], v[52:55], v[68:71], v[84:87]
    s_cmp_eq_u32 s77, 122880
    s_cselect_b32 s79, 4294885376, s98
    v_mfma_f32_16x16x32_bf16 v[88:91], v[56:59], v[68:71], v[88:91]
    s_cselect_b32 s77, 0, s77
    v_add_u32 v4, s79, v4
    v_mfma_f32_16x16x32_bf16 v[92:95], v[60:63], v[68:71], v[92:95]
    v_add_u32 v6, s79, v6
    s_waitcnt lgkmcnt(2)
    v_mfma_f32_16x16x32_bf16 v[96:99], v[48:51], v[72:75], v[96:99]
    ds_read_b64_tr_b16 v[68:69], v8 offset:0
    ds_read_b64_tr_b16 v[70:71], v8 offset:3584
    v_mfma_f32_16x16x32_bf16 v[100:103], v[52:55], v[72:75], v[100:103]
    v_add_u32 v5, s79, v5
    v_add_u32 v7, s79, v7
    v_mfma_f32_16x16x32_bf16 v[104:107], v[56:59], v[72:75], v[104:107]
    v_mfma_f32_16x16x32_bf16 v[108:111], v[60:63], v[72:75], v[108:111]
    s_waitcnt lgkmcnt(3)
    v_mfma_f32_16x16x32_bf16 v[112:115], v[48:51], v[76:79], v[112:115]
    ds_read_b64_tr_b16 v[72:73], v8 offset:32
    ds_read_b64_tr_b16 v[74:75], v8 offset:3616
    v_mfma_f32_16x16x32_bf16 v[116:119], v[52:55], v[76:79], v[116:119]
    ds_read_b128 v[32:35], v4 offset:0
    v_mfma_f32_16x16x32_bf16 v[120:123], v[56:59], v[76:79], v[120:123]
    v_mfma_f32_16x16x32_bf16 v[124:127], v[60:63], v[76:79], v[124:127]
    s_waitcnt lgkmcnt(5)
    v_mfma_f32_16x16x32_bf16 v[128:131], v[48:51], v[64:67], v[128:131]
    ds_read_b64_tr_b16 v[76:77], v8 offset:64
    ds_read_b64_tr_b16 v[78:79], v8 offset:3648
    v_mfma_f32_16x16x32_bf16 v[132:135], v[52:55], v[64:67], v[132:135]
    ds_read_b128 v[36:39], v4 offset:2048
    v_mfma_f32_16x16x32_bf16 v[136:139], v[56:59], v[64:67], v[136:139]
    v_mfma_f32_16x16x32_bf16 v[140:143], v[60:63], v[64:67], v[140:143]
    s_waitcnt lgkmcnt(6)
    v_mfma_f32_16x16x32_bf16 v[144:147], v[68:71], v[48:51], v[144:147]
    ds_read_b64_tr_b16 v[64:65], v8 offset:96
    ds_read_b64_tr_b16 v[66:67], v8 offset:3680
    v_mfma_f32_16x16x32_bf16 v[148:151], v[68:71], v[52:55], v[148:151]
    ds_read_b128 v[40:43], v4 offset:4096
    v_mfma_f32_16x16x32_bf16 v[152:155], v[68:71], v[56:59], v[152:155]
    v_mfma_f32_16x16x32_bf16 v[156:159], v[68:71], v[60:63], v[156:159]
    s_waitcnt lgkmcnt(7)
    v_mfma_f32_16x16x32_bf16 v[160:163], v[72:75], v[48:51], v[160:163]
    ds_read_b64_tr_b16 v[68:69], v8 offset:128
    ds_read_b64_tr_b16 v[70:71], v8 offset:3712
    v_mfma_f32_16x16x32_bf16 v[164:167], v[72:75], v[52:55], v[164:167]
    ds_read_b128 v[44:47], v4 offset:6144
    v_mfma_f32_16x16x32_bf16 v[168:171], v[72:75], v[56:59], v[168:171]
    v_mfma_f32_16x16x32_bf16 v[172:175], v[72:75], v[60:63], v[172:175]
    s_waitcnt lgkmcnt(7)
    v_mfma_f32_16x16x32_bf16 v[176:179], v[76:79], v[48:51], v[176:179]
    ds_read_b64_tr_b16 v[72:73], v8 offset:160
    ds_read_b64_tr_b16 v[74:75], v8 offset:3744
    v_mfma_f32_16x16x32_bf16 v[180:183], v[76:79], v[52:55], v[180:183]
    v_mfma_f32_16x16x32_bf16 v[184:187], v[76:79], v[56:59], v[184:187]
    v_mfma_f32_16x16x32_bf16 v[188:191], v[76:79], v[60:63], v[188:191]
    s_waitcnt lgkmcnt(6)
    v_mfma_f32_16x16x32_bf16 v[192:195], v[64:67], v[48:51], v[192:195]
    ds_read_b64_tr_b16 v[76:77], v9 offset:0
    ds_read_b64_tr_b16 v[78:79], v9 offset:3584
    v_mfma_f32_16x16x32_bf16 v[196:199], v[64:67], v[52:55], v[196:199]
    v_mfma_f32_16x16x32_bf16 v[200:203], v[64:67], v[56:59], v[200:203]
    v_mfma_f32_16x16x32_bf16 v[204:207], v[64:67], v[60:63], v[204:207]
    s_waitcnt lgkmcnt(5)
    v_mfma_f32_16x16x32_bf16 v[208:211], v[68:71], v[48:51], v[208:211]
    ds_read_b128 v[64:67], v6 offset:0
    s_add_u32 s78, s78, 7168
    v_mfma_f32_16x16x32_bf16 v[212:215], v[68:71], v[52:55], v[212:215]
    s_cmp_eq_u32 s78, 35840
    s_cselect_b32 s80, 4294938624, s99
    v_mfma_f32_16x16x32_bf16 v[216:219], v[68:71], v[56:59], v[216:219]
    s_cselect_b32 s78, 0, s78
    v_add_u32 v8, s80, v8
    v_mfma_f32_16x16x32_bf16 v[220:223], v[68:71], v[60:63], v[220:223]
    v_add_u32 v9, s80, v9
    s_waitcnt lgkmcnt(3)
    v_mfma_f32_16x16x32_bf16 v[224:227], v[72:75], v[48:51], v[224:227]
    ds_read_b128 v[68:71], v6 offset:2048
    v_mfma_f32_16x16x32_bf16 v[228:231], v[72:75], v[52:55], v[228:231]
    v_mfma_f32_16x16x32_bf16 v[232:235], v[72:75], v[56:59], v[232:235]
    v_mfma_f32_16x16x32_bf16 v[236:239], v[72:75], v[60:63], v[236:239]
    s_waitcnt lgkmcnt(2)
    v_mfma_f32_16x16x32_bf16 v[240:243], v[76:79], v[48:51], v[240:243]
    ds_read_b128 v[72:75], v6 offset:4096
    v_mfma_f32_16x16x32_bf16 v[244:247], v[76:79], v[52:55], v[244:247]
    v_mfma_f32_16x16x32_bf16 v[248:251], v[76:79], v[56:59], v[248:251]
    v_mfma_f32_16x16x32_bf16 v[252:255], v[76:79], v[60:63], v[252:255]
    s_barrier
    s_cmp_lg_u32 s75, s81
    s_cbranch_scc1 L_k1_kernel_nofl
    s_mov_b64 exec, 1
    buffer_store_byte v19, v18, s[52:55], s74 offen sc0 sc1
    s_mov_b64 exec, -1
L_k1_kernel_nofl:
    s_sub_u32 s75, s75, 1
    s_cmp_lg_u32 s75, 0
    s_cbranch_scc1 L_k1_kernel_loop
    s_waitcnt lgkmcnt(0)
    v_lshlrev_b32 v18, 4, v2
    v_add_u32 v18, 161792, v18
    ds_read_b128 v[4:7], v18
    ds_read_b128 v[8:11], v18 offset:256
    s_lshl_b32 s71, s68, 8
    v_lshlrev_b32 v18, 2, v2
    v_add_u32 v18, s71, v18
    v_add_u32 v18, 158720, v18
    ds_read_b32 v32, v18 offset:0
    ds_read_b32 v33, v18 offset:1024
    ds_read_b32 v34, v18 offset:2048
    ds_read_b32 v36, v18 offset:64
    ds_read_b32 v37, v18 offset:1088
    ds_read_b32 v38, v18 offset:2112
    ds_read_b32 v40, v18 offset:128
    ds_read_b32 v41, v18 offset:1152
    ds_read_b32 v42, v18 offset:2176
    ds_read_b32 v44, v18 offset:192
    ds_read_b32 v45, v18 offset:1216
    ds_read_b32 v46, v18 offset:2240
    v_lshlrev_b32 v19, 4, v3
    v_add_u32 v19, 162816, v19
    s_waitcnt lgkmcnt(12)
    v_fmac_f32 v81, v4, v80
    v_fmac_f32 v113, v4, v112
    v_fmac_f32 v97, v8, v96
    v_fmac_f32 v129, v8, v128
    v_fma_f32 v81, -v5, v112, v81
    v_fmac_f32 v113, v5, v80
    v_fma_f32 v97, -v9, v128, v97
    v_fmac_f32 v129, v9, v96
    v_fmac_f32 v82, v4, v81
    v_fmac_f32 v114, v4, v113
    v_fmac_f32 v98, v8, v97
    v_fmac_f32 v130, v8, v129
    v_fma_f32 v82, -v5, v113, v82
    v_fmac_f32 v114, v5, v81
    v_fma_f32 v98, -v9, v129, v98
    v_fmac_f32 v130, v9, v97
    v_fmac_f32 v83, v4, v82
    v_fmac_f32 v115, v4, v114
    v_fmac_f32 v99, v8, v98
    v_fmac_f32 v131, v8, v130
    v_fma_f32 v83, -v5, v114, v83
    v_fmac_f32 v115, v5, v82
    v_fma_f32 v99, -v9, v130, v99
    v_fmac_f32 v131, v9, v98
    v_fmac_f32 v84, v4, v83
    v_fmac_f32 v116, v4, v115
    v_fmac_f32 v100, v8, v99
    v_fmac_f32 v132, v8, v131
    v_fma_f32 v84, -v5, v115, v84
    v_fmac_f32 v116, v5, v83
    v_fma_f32 v100, -v9, v131, v100
    v_fmac_f32 v132, v9, v99
    v_fmac_f32 v85, v4, v84
    v_fmac_f32 v117, v4, v116
    v_fmac_f32 v101, v8, v100
    v_fmac_f32 v133, v8, v132
    v_fma_f32 v85, -v5, v116, v85
    v_fmac_f32 v117, v5, v84
    v_fma_f32 v101, -v9, v132, v101
    v_fmac_f32 v133, v9, v100
    v_fmac_f32 v86, v4, v85
    v_fmac_f32 v118, v4, v117
    v_fmac_f32 v102, v8, v101
    v_fmac_f32 v134, v8, v133
    v_fma_f32 v86, -v5, v117, v86
    v_fmac_f32 v118, v5, v85
    v_fma_f32 v102, -v9, v133, v102
    v_fmac_f32 v134, v9, v101
    v_fmac_f32 v87, v4, v86
    v_fmac_f32 v119, v4, v118
    v_fmac_f32 v103, v8, v102
    v_fmac_f32 v135, v8, v134
    v_fma_f32 v87, -v5, v118, v87
    v_fmac_f32 v119, v5, v86
    v_fma_f32 v103, -v9, v134, v103
    v_fmac_f32 v135, v9, v102
    v_fmac_f32 v88, v4, v87
    v_fmac_f32 v120, v4, v119
    v_fmac_f32 v104, v8, v103
    v_fmac_f32 v136, v8, v135
    v_fma_f32 v88, -v5, v119, v88
    v_fmac_f32 v120, v5, v87
    v_fma_f32 v104, -v9, v135, v104
    v_fmac_f32 v136, v9, v103
    v_fmac_f32 v89, v4, v88
    v_fmac_f32 v121, v4, v120
    v_fmac_f32 v105, v8, v104
    v_fmac_f32 v137, v8, v136
    v_fma_f32 v89, -v5, v120, v89
    v_fmac_f32 v121, v5, v88
    v_fma_f32 v105, -v9, v136, v105
    v_fmac_f32 v137, v9, v104
    v_fmac_f32 v90, v4, v89
    v_fmac_f32 v122, v4, v121
    v_fmac_f32 v106, v8, v105
    v_fmac_f32 v138, v8, v137
    v_fma_f32 v90, -v5, v121, v90
    v_fmac_f32 v122, v5, v89
    v_fma_f32 v106, -v9, v137, v106
    v_fmac_f32 v138, v9, v105
    v_fmac_f32 v91, v4, v90
    v_fmac_f32 v123, v4, v122
    v_fmac_f32 v107, v8, v106
    v_fmac_f32 v139, v8, v138
    v_fma_f32 v91, -v5, v122, v91
    v_fmac_f32 v123, v5, v90
    v_fma_f32 v107, -v9, v138, v107
    v_fmac_f32 v139, v9, v106
    v_fmac_f32 v92, v4, v91
    v_fmac_f32 v124, v4, v123
    v_fmac_f32 v108, v8, v107
    v_fmac_f32 v140, v8, v139
    v_fma_f32 v92, -v5, v123, v92
    v_fmac_f32 v124, v5, v91
    v_fma_f32 v108, -v9, v139, v108
    v_fmac_f32 v140, v9, v107
    v_fmac_f32 v93, v4, v92
    v_fmac_f32 v125, v4, v124
    v_fmac_f32 v109, v8, v108
    v_fmac_f32 v141, v8, v140
    v_fma_f32 v93, -v5, v124, v93
    v_fmac_f32 v125, v5, v92
    v_fma_f32 v109, -v9, v140, v109
    v_fmac_f32 v141, v9, v108
    v_fmac_f32 v94, v4, v93
    v_fmac_f32 v126, v4, v125
    v_fmac_f32 v110, v8, v109
    v_fmac_f32 v142, v8, v141
    v_fma_f32 v94, -v5, v125, v94
    v_fmac_f32 v126, v5, v93
    v_fma_f32 v110, -v9, v141, v110
    v_fmac_f32 v142, v9, v109
    v_fmac_f32 v95, v4, v94
    v_fmac_f32 v127, v4, v126
    v_fmac_f32 v111, v8, v110
    v_fmac_f32 v143, v8, v142
    v_fma_f32 v95, -v5, v126, v95
    v_fmac_f32 v127, v5, v94
    v_fma_f32 v111, -v9, v142, v111
    v_fmac_f32 v143, v9, v110
    s_lshl_b32 s71, s68, 10
    v_lshlrev_b32 v20, 8, v3
    v_lshlrev_b32 v21, 2, v2
    v_add_u32 v20, v20, v21
    v_add_u32 v20, s71, v20
    v_add_u32 v20, 147456, v20
    ds_write_b32 v20, v95 offset:0
    ds_write_b32 v20, v127 offset:128
    ds_write_b32 v20, v111 offset:64
    ds_write_b32 v20, v143 offset:192
    s_waitcnt lgkmcnt(0)
    s_barrier
    v_sub_f32 v34, 1.0, v34
    v_cvt_pk_bf16_f32 v34, v34, v34
    v_lshlrev_b32 v34, 16, v34
    v_sub_f32 v38, 1.0, v38
    v_cvt_pk_bf16_f32 v38, v38, v38
    v_lshlrev_b32 v38, 16, v38
    v_sub_f32 v42, 1.0, v42
    v_cvt_pk_bf16_f32 v42, v42, v42
    v_lshlrev_b32 v42, 16, v42
    v_sub_f32 v46, 1.0, v46
    v_cvt_pk_bf16_f32 v46, v46, v46
    v_lshlrev_b32 v46, 16, v46
    s_mul_i32 s71, s70, 7
    s_add_u32 s71, s71, 1
    s_lshr_b32 s71, s71, 1
    s_lshl_b32 s71, s71, 10
    v_lshlrev_b32 v21, 4, v1
    v_add_u32 v22, s71, v21
    s_add_u32 s72, s71, 3072
    s_sub_u32 s73, s71, 1016
    s_cmp_eq_u32 s76, 0
    s_cselect_b32 s72, s72, s73
    v_add_u32 v23, s72, v21
    s_lshr_b32 s72, s70, 1
    s_lshl_b32 s72, s72, 2
    s_add_u32 s72, s72, s76
    s_add_u32 s72, s72, 112
    s_lshl_b32 s72, s72, 10
    v_add_u32 v24, s72, v21
    s_lshl_b32 s72, s69, 4
    s_lshl_b32 s73, s68, 2
    s_add_u32 s72, s72, s73
    s_mul_i32 s90, s72, 180224
    s_add_u32 s91, s90, 180224
    s_add_u32 s92, s91, 180224
    s_add_u32 s93, s92, 180224
    s_mov_b32 s82, 0xc0135761
    s_mov_b32 s83, 0xc0135761
    s_mov_b32 s84, 0xbdd2d3e8
    s_mov_b32 s85, 0xbdd2d3e8
    s_mov_b32 s86, 1.0
    s_mov_b32 s87, 1.0
    v_mov_b32 v26, s82
    v_mov_b32 v27, s82
    ds_read_b128 v[48:51], v19 offset:0
    ds_read_b128 v[56:59], v19 offset:448
    ds_read_b128 v[52:55], v19 offset:64
    ds_read_b128 v[60:63], v19 offset:512
    s_waitcnt lgkmcnt(0)
    v_pk_fma_f32 v[64:65], v[32:33], v[48:49], v[56:57] op_sel:[1,0,0] op_sel_hi:[1,1,1] neg_lo:[1,0,0] neg_hi:[1,0,0]
    v_pk_fma_f32 v[66:67], v[32:33], v[50:51], v[58:59] op_sel:[1,0,0] op_sel_hi:[1,1,1] neg_lo:[1,0,0] neg_hi:[1,0,0]
    v_pk_fma_f32 v[68:69], v[32:33], v[52:53], v[60:61] op_sel:[1,0,0] op_sel_hi:[1,1,1] neg_lo:[1,0,0] neg_hi:[1,0,0]
    v_pk_fma_f32 v[70:71], v[32:33], v[54:55], v[62:63] op_sel:[1,0,0] op_sel_hi:[1,1,1] neg_lo:[1,0,0] neg_hi:[1,0,0]
    v_pk_fma_f32 v[144:145], v[32:33], v[144:145], v[64:65] op_sel:[0,0,0] op_sel_hi:[0,1,1]
    v_pk_fma_f32 v[146:147], v[32:33], v[146:147], v[66:67] op_sel:[0,0,0] op_sel_hi:[0,1,1]
    v_pk_fma_f32 v[160:161], v[32:33], v[160:161], v[68:69] op_sel:[0,0,0] op_sel_hi:[0,1,1]
    v_pk_fma_f32 v[162:163], v[32:33], v[162:163], v[70:71] op_sel:[0,0,0] op_sel_hi:[0,1,1]
    v_pk_mul_f32 v[64:65], v[144:145], v[144:145]
    v_pk_mul_f32 v[66:67], v[146:147], v[146:147]
    v_pk_mul_f32 v[68:69], v[160:161], v[160:161]
    v_pk_mul_f32 v[70:71], v[162:163], v[162:163]
    v_pk_fma_f32 v[64:65], v[64:65], s[84:85], v[26:27]
    v_pk_fma_f32 v[66:67], v[66:67], s[84:85], v[26:27]
    v_pk_fma_f32 v[68:69], v[68:69], s[84:85], v[26:27]
    v_pk_fma_f32 v[70:71], v[70:71], s[84:85], v[26:27]
    v_pk_mul_f32 v[64:65], v[64:65], v[144:145]
    v_pk_mul_f32 v[66:67], v[66:67], v[146:147]
    v_pk_mul_f32 v[68:69], v[68:69], v[160:161]
    v_pk_mul_f32 v[70:71], v[70:71], v[162:163]
    v_exp_f32 v64, v64
    v_exp_f32 v65, v65
    v_exp_f32 v66, v66
    v_exp_f32 v67, v67
    v_exp_f32 v68, v68
    v_exp_f32 v69, v69
    v_exp_f32 v70, v70
    v_exp_f32 v71, v71
    v_pk_mul_f32 v[144:145], v[34:35], v[144:145] op_sel:[0,0] op_sel_hi:[0,1]
    v_pk_mul_f32 v[146:147], v[34:35], v[146:147] op_sel:[0,0] op_sel_hi:[0,1]
    v_pk_mul_f32 v[160:161], v[34:35], v[160:161] op_sel:[0,0] op_sel_hi:[0,1]
    v_pk_mul_f32 v[162:163], v[34:35], v[162:163] op_sel:[0,0] op_sel_hi:[0,1]
    v_pk_add_f32 v[64:65], v[64:65], s[86:87]
    v_pk_add_f32 v[66:67], v[66:67], s[86:87]
    v_pk_add_f32 v[68:69], v[68:69], s[86:87]
    v_pk_add_f32 v[70:71], v[70:71], s[86:87]
    v_rcp_f32 v64, v64
    v_rcp_f32 v65, v65
    v_rcp_f32 v66, v66
    v_rcp_f32 v67, v67
    v_rcp_f32 v68, v68
    v_rcp_f32 v69, v69
    v_rcp_f32 v70, v70
    v_rcp_f32 v71, v71
    s_nop 0
    v_pk_mul_f32 v[144:145], v[144:145], v[64:65]
    v_pk_mul_f32 v[146:147], v[146:147], v[66:67]
    v_pk_mul_f32 v[160:161], v[160:161], v[68:69]
    v_pk_mul_f32 v[162:163], v[162:163], v[70:71]
    v_cvt_pk_bf16_f32 v144, v144, v145
    v_cvt_pk_bf16_f32 v145, v146, v147
    v_cvt_pk_bf16_f32 v146, v160, v161
    v_cvt_pk_bf16_f32 v147, v162, v163
    buffer_store_dwordx4 v[144:147], v22, s[48:51], s90 offen offset:0 sc0 sc1
    v_pk_fma_f32 v[64:65], v[36:37], v[48:49], v[56:57] op_sel:[1,0,0] op_sel_hi:[1,1,1] neg_lo:[1,0,0] neg_hi:[1,0,0]
    v_pk_fma_f32 v[66:67], v[36:37], v[50:51], v[58:59] op_sel:[1,0,0] op_sel_hi:[1,1,1] neg_lo:[1,0,0] neg_hi:[1,0,0]
    v_pk_fma_f32 v[68:69], v[36:37], v[52:53], v[60:61] op_sel:[1,0,0] op_sel_hi:[1,1,1] neg_lo:[1,0,0] neg_hi:[1,0,0]
    v_pk_fma_f32 v[70:71], v[36:37], v[54:55], v[62:63] op_sel:[1,0,0] op_sel_hi:[1,1,1] neg_lo:[1,0,0] neg_hi:[1,0,0]
    v_pk_fma_f32 v[148:149], v[36:37], v[148:149], v[64:65] op_sel:[0,0,0] op_sel_hi:[0,1,1]
    v_pk_fma_f32 v[150:151], v[36:37], v[150:151], v[66:67] op_sel:[0,0,0] op_sel_hi:[0,1,1]
    v_pk_fma_f32 v[164:165], v[36:37], v[164:165], v[68:69] op_sel:[0,0,0] op_sel_hi:[0,1,1]
    v_pk_fma_f32 v[166:167], v[36:37], v[166:167], v[70:71] op_sel:[0,0,0] op_sel_hi:[0,1,1]
    v_pk_mul_f32 v[64:65], v[148:149], v[148:149]
    v_pk_mul_f32 v[66:67], v[150:151], v[150:151]
    v_pk_mul_f32 v[68:69], v[164:165], v[164:165]
    v_pk_mul_f32 v[70:71], v[166:167], v[166:167]
    v_pk_fma_f32 v[64:65], v[64:65], s[84:85], v[26:27]
    v_pk_fma_f32 v[66:67], v[66:67], s[84:85], v[26:27]
    v_pk_fma_f32 v[68:69], v[68:69], s[84:85], v[26:27]
    v_pk_fma_f32 v[70:71], v[70:71], s[84:85], v[26:27]
    v_pk_mul_f32 v[64:65], v[64:65], v[148:149]
    v_pk_mul_f32 v[66:67], v[66:67], v[150:151]
    v_pk_mul_f32 v[68:69], v[68:69], v[164:165]
    v_pk_mul_f32 v[70:71], v[70:71], v[166:167]
    v_exp_f32 v64, v64
    v_exp_f32 v65, v65
    v_exp_f32 v66, v66
    v_exp_f32 v67, v67
    v_exp_f32 v68, v68
    v_exp_f32 v69, v69
    v_exp_f32 v70, v70
    v_exp_f32 v71, v71
    v_pk_mul_f32 v[148:149], v[38:39], v[148:149] op_sel:[0,0] op_sel_hi:[0,1]
    v_pk_mul_f32 v[150:151], v[38:39], v[150:151] op_sel:[0,0] op_sel_hi:[0,1]
    v_pk_mul_f32 v[164:165], v[38:39], v[164:165] op_sel:[0,0] op_sel_hi:[0,1]
    v_pk_mul_f32 v[166:167], v[38:39], v[166:167] op_sel:[0,0] op_sel_hi:[0,1]
    v_pk_add_f32 v[64:65], v[64:65], s[86:87]
    v_pk_add_f32 v[66:67], v[66:67], s[86:87]
    v_pk_add_f32 v[68:69], v[68:69], s[86:87]
    v_pk_add_f32 v[70:71], v[70:71], s[86:87]
    v_rcp_f32 v64, v64
    v_rcp_f32 v65, v65
    v_rcp_f32 v66, v66
    v_rcp_f32 v67, v67
    v_rcp_f32 v68, v68
    v_rcp_f32 v69, v69
    v_rcp_f32 v70, v70
    v_rcp_f32 v71, v71
    s_nop 0
    v_pk_mul_f32 v[148:149], v[148:149], v[64:65]
    v_pk_mul_f32 v[150:151], v[150:151], v[66:67]
    v_pk_mul_f32 v[164:165], v[164:165], v[68:69]
    v_pk_mul_f32 v[166:167], v[166:167], v[70:71]
    v_cvt_pk_bf16_f32 v148, v148, v149
    v_cvt_pk_bf16_f32 v149, v150, v151
    v_cvt_pk_bf16_f32 v150, v164, v165
    v_cvt_pk_bf16_f32 v151, v166, v167
    buffer_store_dwordx4 v[148:151], v22, s[48:51], s91 offen offset:0 sc0 sc1
    v_pk_fma_f32 v[64:65], v[40:41], v[48:49], v[56:57] op_sel:[1,0,0] op_sel_hi:[1,1,1] neg_lo:[1,0,0] neg_hi:[1,0,0]
    v_pk_fma_f32 v[66:67], v[40:41], v[50:51], v[58:59] op_sel:[1,0,0] op_sel_hi:[1,1,1] neg_lo:[1,0,0] neg_hi:[1,0,0]
    v_pk_fma_f32 v[68:69], v[40:41], v[52:53], v[60:61] op_sel:[1,0,0] op_sel_hi:[1,1,1] neg_lo:[1,0,0] neg_hi:[1,0,0]
    v_pk_fma_f32 v[70:71], v[40:41], v[54:55], v[62:63] op_sel:[1,0,0] op_sel_hi:[1,1,1] neg_lo:[1,0,0] neg_hi:[1,0,0]
    v_pk_fma_f32 v[152:153], v[40:41], v[152:153], v[64:65] op_sel:[0,0,0] op_sel_hi:[0,1,1]
    v_pk_fma_f32 v[154:155], v[40:41], v[154:155], v[66:67] op_sel:[0,0,0] op_sel_hi:[0,1,1]
    v_pk_fma_f32 v[168:169], v[40:41], v[168:169], v[68:69] op_sel:[0,0,0] op_sel_hi:[0,1,1]
    v_pk_fma_f32 v[170:171], v[40:41], v[170:171], v[70:71] op_sel:[0,0,0] op_sel_hi:[0,1,1]
    v_pk_mul_f32 v[64:65], v[152:153], v[152:153]
    v_pk_mul_f32 v[66:67], v[154:155], v[154:155]
    v_pk_mul_f32 v[68:69], v[168:169], v[168:169]
    v_pk_mul_f32 v[70:71], v[170:171], v[170:171]
    v_pk_fma_f32 v[64:65], v[64:65], s[84:85], v[26:27]
    v_pk_fma_f32 v[66:67], v[66:67], s[84:85], v[26:27]
    v_pk_fma_f32 v[68:69], v[68:69], s[84:85], v[26:27]
    v_pk_fma_f32 v[70:71], v[70:71], s[84:85], v[26:27]
    v_pk_mul_f32 v[64:65], v[64:65], v[152:153]
    v_pk_mul_f32 v[66:67], v[66:67], v[154:155]
    v_pk_mul_f32 v[68:69], v[68:69], v[168:169]
    v_pk_mul_f32 v[70:71], v[70:71], v[170:171]
    v_exp_f32 v64, v64
    v_exp_f32 v65, v65
    v_exp_f32 v66, v66
    v_exp_f32 v67, v67
    v_exp_f32 v68, v68
    v_exp_f32 v69, v69
    v_exp_f32 v70, v70
    v_exp_f32 v71, v71
    v_pk_mul_f32 v[152:153], v[42:43], v[152:153] op_sel:[0,0] op_sel_hi:[0,1]
    v_pk_mul_f32 v[154:155], v[42:43], v[154:155] op_sel:[0,0] op_sel_hi:[0,1]
    v_pk_mul_f32 v[168:169], v[42:43], v[168:169] op_sel:[0,0] op_sel_hi:[0,1]
    v_pk_mul_f32 v[170:171], v[42:43], v[170:171] op_sel:[0,0] op_sel_hi:[0,1]
    v_pk_add_f32 v[64:65], v[64:65], s[86:87]
    v_pk_add_f32 v[66:67], v[66:67], s[86:87]
    v_pk_add_f32 v[68:69], v[68:69], s[86:87]
    v_pk_add_f32 v[70:71], v[70:71], s[86:87]
    v_rcp_f32 v64, v64
    v_rcp_f32 v65, v65
    v_rcp_f32 v66, v66
    v_rcp_f32 v67, v67
    v_rcp_f32 v68, v68
    v_rcp_f32 v69, v69
    v_rcp_f32 v70, v70
    v_rcp_f32 v71, v71
    s_nop 0
    v_pk_mul_f32 v[152:153], v[152:153], v[64:65]
    v_pk_mul_f32 v[154:155], v[154:155], v[66:67]
    v_pk_mul_f32 v[168:169], v[168:169], v[68:69]
    v_pk_mul_f32 v[170:171], v[170:171], v[70:71]
    v_cvt_pk_bf16_f32 v152, v152, v153
    v_cvt_pk_bf16_f32 v153, v154, v155
    v_cvt_pk_bf16_f32 v154, v168, v169
    v_cvt_pk_bf16_f32 v155, v170, v171
    buffer_store_dwordx4 v[152:155], v22, s[48:51], s92 offen offset:0 sc0 sc1
    v_pk_fma_f32 v[64:65], v[44:45], v[48:49], v[56:57] op_sel:[1,0,0] op_sel_hi:[1,1,1] neg_lo:[1,0,0] neg_hi:[1,0,0]
    v_pk_fma_f32 v[66:67], v[44:45], v[50:51], v[58:59] op_sel:[1,0,0] op_sel_hi:[1,1,1] neg_lo:[1,0,0] neg_hi:[1,0,0]
    v_pk_fma_f32 v[68:69], v[44:45], v[52:53], v[60:61] op_sel:[1,0,0] op_sel_hi:[1,1,1] neg_lo:[1,0,0] neg_hi:[1,0,0]
    v_pk_fma_f32 v[70:71], v[44:45], v[54:55], v[62:63] op_sel:[1,0,0] op_sel_hi:[1,1,1] neg_lo:[1,0,0] neg_hi:[1,0,0]
    v_pk_fma_f32 v[156:157], v[44:45], v[156:157], v[64:65] op_sel:[0,0,0] op_sel_hi:[0,1,1]
    v_pk_fma_f32 v[158:159], v[44:45], v[158:159], v[66:67] op_sel:[0,0,0] op_sel_hi:[0,1,1]
    v_pk_fma_f32 v[172:173], v[44:45], v[172:173], v[68:69] op_sel:[0,0,0] op_sel_hi:[0,1,1]
    v_pk_fma_f32 v[174:175], v[44:45], v[174:175], v[70:71] op_sel:[0,0,0] op_sel_hi:[0,1,1]
    v_pk_mul_f32 v[64:65], v[156:157], v[156:157]
    v_pk_mul_f32 v[66:67], v[158:159], v[158:159]
    v_pk_mul_f32 v[68:69], v[172:173], v[172:173]
    v_pk_mul_f32 v[70:71], v[174:175], v[174:175]
    v_pk_fma_f32 v[64:65], v[64:65], s[84:85], v[26:27]
    v_pk_fma_f32 v[66:67], v[66:67], s[84:85], v[26:27]
    v_pk_fma_f32 v[68:69], v[68:69], s[84:85], v[26:27]
    v_pk_fma_f32 v[70:71], v[70:71], s[84:85], v[26:27]
    v_pk_mul_f32 v[64:65], v[64:65], v[156:157]
    v_pk_mul_f32 v[66:67], v[66:67], v[158:159]
    v_pk_mul_f32 v[68:69], v[68:69], v[172:173]
    v_pk_mul_f32 v[70:71], v[70:71], v[174:175]
    v_exp_f32 v64, v64
    v_exp_f32 v65, v65
    v_exp_f32 v66, v66
    v_exp_f32 v67, v67
    v_exp_f32 v68, v68
    v_exp_f32 v69, v69
    v_exp_f32 v70, v70
    v_exp_f32 v71, v71
    v_pk_mul_f32 v[156:157], v[46:47], v[156:157] op_sel:[0,0] op_sel_hi:[0,1]
    v_pk_mul_f32 v[158:159], v[46:47], v[158:159] op_sel:[0,0] op_sel_hi:[0,1]
    v_pk_mul_f32 v[172:173], v[46:47], v[172:173] op_sel:[0,0] op_sel_hi:[0,1]
    v_pk_mul_f32 v[174:175], v[46:47], v[174:175] op_sel:[0,0] op_sel_hi:[0,1]
    v_pk_add_f32 v[64:65], v[64:65], s[86:87]
    v_pk_add_f32 v[66:67], v[66:67], s[86:87]
    v_pk_add_f32 v[68:69], v[68:69], s[86:87]
    v_pk_add_f32 v[70:71], v[70:71], s[86:87]
    v_rcp_f32 v64, v64
    v_rcp_f32 v65, v65
    v_rcp_f32 v66, v66
    v_rcp_f32 v67, v67
    v_rcp_f32 v68, v68
    v_rcp_f32 v69, v69
    v_rcp_f32 v70, v70
    v_rcp_f32 v71, v71
    s_nop 0
    v_pk_mul_f32 v[156:157], v[156:157], v[64:65]
    v_pk_mul_f32 v[158:159], v[158:159], v[66:67]
    v_pk_mul_f32 v[172:173], v[172:173], v[68:69]
    v_pk_mul_f32 v[174:175], v[174:175], v[70:71]
    v_cvt_pk_bf16_f32 v156, v156, v157
    v_cvt_pk_bf16_f32 v157, v158, v159
    v_cvt_pk_bf16_f32 v158, v172, v173
    v_cvt_pk_bf16_f32 v159, v174, v175
    buffer_store_dwordx4 v[156:159], v22, s[48:51], s93 offen offset:0 sc0 sc1
    ds_read_b128 v[48:51], v19 offset:128
    ds_read_b128 v[56:59], v19 offset:576
    ds_read_b128 v[52:55], v19 offset:192
    ds_read_b128 v[60:63], v19 offset:640
    s_waitcnt lgkmcnt(0)
    v_pk_fma_f32 v[64:65], v[32:33], v[48:49], v[56:57] op_sel:[1,0,0] op_sel_hi:[1,1,1] neg_lo:[1,0,0] neg_hi:[1,0,0]
    v_pk_fma_f32 v[66:67], v[32:33], v[50:51], v[58:59] op_sel:[1,0,0] op_sel_hi:[1,1,1] neg_lo:[1,0,0] neg_hi:[1,0,0]
    v_pk_fma_f32 v[68:69], v[32:33], v[52:53], v[60:61] op_sel:[1,0,0] op_sel_hi:[1,1,1] neg_lo:[1,0,0] neg_hi:[1,0,0]
    v_pk_fma_f32 v[70:71], v[32:33], v[54:55], v[62:63] op_sel:[1,0,0] op_sel_hi:[1,1,1] neg_lo:[1,0,0] neg_hi:[1,0,0]
    v_pk_fma_f32 v[176:177], v[32:33], v[176:177], v[64:65] op_sel:[0,0,0] op_sel_hi:[0,1,1]
    v_pk_fma_f32 v[178:179], v[32:33], v[178:179], v[66:67] op_sel:[0,0,0] op_sel_hi:[0,1,1]
    v_pk_fma_f32 v[192:193], v[32:33], v[192:193], v[68:69] op_sel:[0,0,0] op_sel_hi:[0,1,1]
    v_pk_fma_f32 v[194:195], v[32:33], v[194:195], v[70:71] op_sel:[0,0,0] op_sel_hi:[0,1,1]
    v_pk_mul_f32 v[64:65], v[176:177], v[176:177]
    v_pk_mul_f32 v[66:67], v[178:179], v[178:179]
    v_pk_mul_f32 v[68:69], v[192:193], v[192:193]
    v_pk_mul_f32 v[70:71], v[194:195], v[194:195]
    v_pk_fma_f32 v[64:65], v[64:65], s[84:85], v[26:27]
    v_pk_fma_f32 v[66:67], v[66:67], s[84:85], v[26:27]
    v_pk_fma_f32 v[68:69], v[68:69], s[84:85], v[26:27]
    v_pk_fma_f32 v[70:71], v[70:71], s[84:85], v[26:27]
    v_pk_mul_f32 v[64:65], v[64:65], v[176:177]
    v_pk_mul_f32 v[66:67], v[66:67], v[178:179]
    v_pk_mul_f32 v[68:69], v[68:69], v[192:193]
    v_pk_mul_f32 v[70:71], v[70:71], v[194:195]
    v_exp_f32 v64, v64
    v_exp_f32 v65, v65
    v_exp_f32 v66, v66
    v_exp_f32 v67, v67
    v_exp_f32 v68, v68
    v_exp_f32 v69, v69
    v_exp_f32 v70, v70
    v_exp_f32 v71, v71
    v_pk_mul_f32 v[176:177], v[34:35], v[176:177] op_sel:[0,0] op_sel_hi:[0,1]
    v_pk_mul_f32 v[178:179], v[34:35], v[178:179] op_sel:[0,0] op_sel_hi:[0,1]
    v_pk_mul_f32 v[192:193], v[34:35], v[192:193] op_sel:[0,0] op_sel_hi:[0,1]
    v_pk_mul_f32 v[194:195], v[34:35], v[194:195] op_sel:[0,0] op_sel_hi:[0,1]
    v_pk_add_f32 v[64:65], v[64:65], s[86:87]
    v_pk_add_f32 v[66:67], v[66:67], s[86:87]
    v_pk_add_f32 v[68:69], v[68:69], s[86:87]
    v_pk_add_f32 v[70:71], v[70:71], s[86:87]
    v_rcp_f32 v64, v64
    v_rcp_f32 v65, v65
    v_rcp_f32 v66, v66
    v_rcp_f32 v67, v67
    v_rcp_f32 v68, v68
    v_rcp_f32 v69, v69
    v_rcp_f32 v70, v70
    v_rcp_f32 v71, v71
    s_nop 0
    v_pk_mul_f32 v[176:177], v[176:177], v[64:65]
    v_pk_mul_f32 v[178:179], v[178:179], v[66:67]
    v_pk_mul_f32 v[192:193], v[192:193], v[68:69]
    v_pk_mul_f32 v[194:195], v[194:195], v[70:71]
    v_cvt_pk_bf16_f32 v176, v176, v177
    v_cvt_pk_bf16_f32 v177, v178, v179
    v_cvt_pk_bf16_f32 v178, v192, v193
    v_cvt_pk_bf16_f32 v179, v194, v195
    buffer_store_dwordx4 v[176:179], v22, s[48:51], s90 offen offset:1024 sc0 sc1
    v_pk_fma_f32 v[64:65], v[36:37], v[48:49], v[56:57] op_sel:[1,0,0] op_sel_hi:[1,1,1] neg_lo:[1,0,0] neg_hi:[1,0,0]
    v_pk_fma_f32 v[66:67], v[36:37], v[50:51], v[58:59] op_sel:[1,0,0] op_sel_hi:[1,1,1] neg_lo:[1,0,0] neg_hi:[1,0,0]
    v_pk_fma_f32 v[68:69], v[36:37], v[52:53], v[60:61] op_sel:[1,0,0] op_sel_hi:[1,1,1] neg_lo:[1,0,0] neg_hi:[1,0,0]
    v_pk_fma_f32 v[70:71], v[36:37], v[54:55], v[62:63] op_sel:[1,0,0] op_sel_hi:[1,1,1] neg_lo:[1,0,0] neg_hi:[1,0,0]
    v_pk_fma_f32 v[180:181], v[36:37], v[180:181], v[64:65] op_sel:[0,0,0] op_sel_hi:[0,1,1]
    v_pk_fma_f32 v[182:183], v[36:37], v[182:183], v[66:67] op_sel:[0,0,0] op_sel_hi:[0,1,1]
    v_pk_fma_f32 v[196:197], v[36:37], v[196:197], v[68:69] op_sel:[0,0,0] op_sel_hi:[0,1,1]
    v_pk_fma_f32 v[198:199], v[36:37], v[198:199], v[70:71] op_sel:[0,0,0] op_sel_hi:[0,1,1]
    v_pk_mul_f32 v[64:65], v[180:181], v[180:181]
    v_pk_mul_f32 v[66:67], v[182:183], v[182:183]
    v_pk_mul_f32 v[68:69], v[196:197], v[196:197]
    v_pk_mul_f32 v[70:71], v[198:199], v[198:199]
    v_pk_fma_f32 v[64:65], v[64:65], s[84:85], v[26:27]
    v_pk_fma_f32 v[66:67], v[66:67], s[84:85], v[26:27]
    v_pk_fma_f32 v[68:69], v[68:69], s[84:85], v[26:27]
    v_pk_fma_f32 v[70:71], v[70:71], s[84:85], v[26:27]
    v_pk_mul_f32 v[64:65], v[64:65], v[180:181]
    v_pk_mul_f32 v[66:67], v[66:67], v[182:183]
    v_pk_mul_f32 v[68:69], v[68:69], v[196:197]
    v_pk_mul_f32 v[70:71], v[70:71], v[198:199]
    v_exp_f32 v64, v64
    v_exp_f32 v65, v65
    v_exp_f32 v66, v66
    v_exp_f32 v67, v67
    v_exp_f32 v68, v68
    v_exp_f32 v69, v69
    v_exp_f32 v70, v70
    v_exp_f32 v71, v71
    v_pk_mul_f32 v[180:181], v[38:39], v[180:181] op_sel:[0,0] op_sel_hi:[0,1]
    v_pk_mul_f32 v[182:183], v[38:39], v[182:183] op_sel:[0,0] op_sel_hi:[0,1]
    v_pk_mul_f32 v[196:197], v[38:39], v[196:197] op_sel:[0,0] op_sel_hi:[0,1]
    v_pk_mul_f32 v[198:199], v[38:39], v[198:199] op_sel:[0,0] op_sel_hi:[0,1]
    v_pk_add_f32 v[64:65], v[64:65], s[86:87]
    v_pk_add_f32 v[66:67], v[66:67], s[86:87]
    v_pk_add_f32 v[68:69], v[68:69], s[86:87]
    v_pk_add_f32 v[70:71], v[70:71], s[86:87]
    v_rcp_f32 v64, v64
    v_rcp_f32 v65, v65
    v_rcp_f32 v66, v66
    v_rcp_f32 v67, v67
    v_rcp_f32 v68, v68
    v_rcp_f32 v69, v69
    v_rcp_f32 v70, v70
    v_rcp_f32 v71, v71
    s_nop 0
    v_pk_mul_f32 v[180:181], v[180:181], v[64:65]
    v_pk_mul_f32 v[182:183], v[182:183], v[66:67]
    v_pk_mul_f32 v[196:197], v[196:197], v[68:69]
    v_pk_mul_f32 v[198:199], v[198:199], v[70:71]
    v_cvt_pk_bf16_f32 v180, v180, v181
    v_cvt_pk_bf16_f32 v181, v182, v183
    v_cvt_pk_bf16_f32 v182, v196, v197
    v_cvt_pk_bf16_f32 v183, v198, v199
    buffer_store_dwordx4 v[180:183], v22, s[48:51], s91 offen offset:1024 sc0 sc1
    v_pk_fma_f32 v[64:65], v[40:41], v[48:49], v[56:57] op_sel:[1,0,0] op_sel_hi:[1,1,1] neg_lo:[1,0,0] neg_hi:[1,0,0]
    v_pk_fma_f32 v[66:67], v[40:41], v[50:51], v[58:59] op_sel:[1,0,0] op_sel_hi:[1,1,1] neg_lo:[1,0,0] neg_hi:[1,0,0]
    v_pk_fma_f32 v[68:69], v[40:41], v[52:53], v[60:61] op_sel:[1,0,0] op_sel_hi:[1,1,1] neg_lo:[1,0,0] neg_hi:[1,0,0]
    v_pk_fma_f32 v[70:71], v[40:41], v[54:55], v[62:63] op_sel:[1,0,0] op_sel_hi:[1,1,1] neg_lo:[1,0,0] neg_hi:[1,0,0]
    v_pk_fma_f32 v[184:185], v[40:41], v[184:185], v[64:65] op_sel:[0,0,0] op_sel_hi:[0,1,1]
    v_pk_fma_f32 v[186:187], v[40:41], v[186:187], v[66:67] op_sel:[0,0,0] op_sel_hi:[0,1,1]
    v_pk_fma_f32 v[200:201], v[40:41], v[200:201], v[68:69] op_sel:[0,0,0] op_sel_hi:[0,1,1]
    v_pk_fma_f32 v[202:203], v[40:41], v[202:203], v[70:71] op_sel:[0,0,0] op_sel_hi:[0,1,1]
    v_pk_mul_f32 v[64:65], v[184:185], v[184:185]
    v_pk_mul_f32 v[66:67], v[186:187], v[186:187]
    v_pk_mul_f32 v[68:69], v[200:201], v[200:201]
    v_pk_mul_f32 v[70:71], v[202:203], v[202:203]
    v_pk_fma_f32 v[64:65], v[64:65], s[84:85], v[26:27]
    v_pk_fma_f32 v[66:67], v[66:67], s[84:85], v[26:27]
    v_pk_fma_f32 v[68:69], v[68:69], s[84:85], v[26:27]
    v_pk_fma_f32 v[70:71], v[70:71], s[84:85], v[26:27]
    v_pk_mul_f32 v[64:65], v[64:65], v[184:185]
    v_pk_mul_f32 v[66:67], v[66:67], v[186:187]
    v_pk_mul_f32 v[68:69], v[68:69], v[200:201]
    v_pk_mul_f32 v[70:71], v[70:71], v[202:203]
    v_exp_f32 v64, v64
    v_exp_f32 v65, v65
    v_exp_f32 v66, v66
    v_exp_f32 v67, v67
    v_exp_f32 v68, v68
    v_exp_f32 v69, v69
    v_exp_f32 v70, v70
    v_exp_f32 v71, v71
    v_pk_mul_f32 v[184:185], v[42:43], v[184:185] op_sel:[0,0] op_sel_hi:[0,1]
    v_pk_mul_f32 v[186:187], v[42:43], v[186:187] op_sel:[0,0] op_sel_hi:[0,1]
    v_pk_mul_f32 v[200:201], v[42:43], v[200:201] op_sel:[0,0] op_sel_hi:[0,1]
    v_pk_mul_f32 v[202:203], v[42:43], v[202:203] op_sel:[0,0] op_sel_hi:[0,1]
    v_pk_add_f32 v[64:65], v[64:65], s[86:87]
    v_pk_add_f32 v[66:67], v[66:67], s[86:87]
    v_pk_add_f32 v[68:69], v[68:69], s[86:87]
    v_pk_add_f32 v[70:71], v[70:71], s[86:87]
    v_rcp_f32 v64, v64
    v_rcp_f32 v65, v65
    v_rcp_f32 v66, v66
    v_rcp_f32 v67, v67
    v_rcp_f32 v68, v68
    v_rcp_f32 v69, v69
    v_rcp_f32 v70, v70
    v_rcp_f32 v71, v71
    s_nop 0
    v_pk_mul_f32 v[184:185], v[184:185], v[64:65]
    v_pk_mul_f32 v[186:187], v[186:187], v[66:67]
    v_pk_mul_f32 v[200:201], v[200:201], v[68:69]
    v_pk_mul_f32 v[202:203], v[202:203], v[70:71]
    v_cvt_pk_bf16_f32 v184, v184, v185
    v_cvt_pk_bf16_f32 v185, v186, v187
    v_cvt_pk_bf16_f32 v186, v200, v201
    v_cvt_pk_bf16_f32 v187, v202, v203
    buffer_store_dwordx4 v[184:187], v22, s[48:51], s92 offen offset:1024 sc0 sc1
    v_pk_fma_f32 v[64:65], v[44:45], v[48:49], v[56:57] op_sel:[1,0,0] op_sel_hi:[1,1,1] neg_lo:[1,0,0] neg_hi:[1,0,0]
    v_pk_fma_f32 v[66:67], v[44:45], v[50:51], v[58:59] op_sel:[1,0,0] op_sel_hi:[1,1,1] neg_lo:[1,0,0] neg_hi:[1,0,0]
    v_pk_fma_f32 v[68:69], v[44:45], v[52:53], v[60:61] op_sel:[1,0,0] op_sel_hi:[1,1,1] neg_lo:[1,0,0] neg_hi:[1,0,0]
    v_pk_fma_f32 v[70:71], v[44:45], v[54:55], v[62:63] op_sel:[1,0,0] op_sel_hi:[1,1,1] neg_lo:[1,0,0] neg_hi:[1,0,0]
    v_pk_fma_f32 v[188:189], v[44:45], v[188:189], v[64:65] op_sel:[0,0,0] op_sel_hi:[0,1,1]
    v_pk_fma_f32 v[190:191], v[44:45], v[190:191], v[66:67] op_sel:[0,0,0] op_sel_hi:[0,1,1]
    v_pk_fma_f32 v[204:205], v[44:45], v[204:205], v[68:69] op_sel:[0,0,0] op_sel_hi:[0,1,1]
    v_pk_fma_f32 v[206:207], v[44:45], v[206:207], v[70:71] op_sel:[0,0,0] op_sel_hi:[0,1,1]
    v_pk_mul_f32 v[64:65], v[188:189], v[188:189]
    v_pk_mul_f32 v[66:67], v[190:191], v[190:191]
    v_pk_mul_f32 v[68:69], v[204:205], v[204:205]
    v_pk_mul_f32 v[70:71], v[206:207], v[206:207]
    v_pk_fma_f32 v[64:65], v[64:65], s[84:85], v[26:27]
    v_pk_fma_f32 v[66:67], v[66:67], s[84:85], v[26:27]
    v_pk_fma_f32 v[68:69], v[68:69], s[84:85], v[26:27]
    v_pk_fma_f32 v[70:71], v[70:71], s[84:85], v[26:27]
    v_pk_mul_f32 v[64:65], v[64:65], v[188:189]
    v_pk_mul_f32 v[66:67], v[66:67], v[190:191]
    v_pk_mul_f32 v[68:69], v[68:69], v[204:205]
    v_pk_mul_f32 v[70:71], v[70:71], v[206:207]
    v_exp_f32 v64, v64
    v_exp_f32 v65, v65
    v_exp_f32 v66, v66
    v_exp_f32 v67, v67
    v_exp_f32 v68, v68
    v_exp_f32 v69, v69
    v_exp_f32 v70, v70
    v_exp_f32 v71, v71
    v_pk_mul_f32 v[188:189], v[46:47], v[188:189] op_sel:[0,0] op_sel_hi:[0,1]
    v_pk_mul_f32 v[190:191], v[46:47], v[190:191] op_sel:[0,0] op_sel_hi:[0,1]
    v_pk_mul_f32 v[204:205], v[46:47], v[204:205] op_sel:[0,0] op_sel_hi:[0,1]
    v_pk_mul_f32 v[206:207], v[46:47], v[206:207] op_sel:[0,0] op_sel_hi:[0,1]
    v_pk_add_f32 v[64:65], v[64:65], s[86:87]
    v_pk_add_f32 v[66:67], v[66:67], s[86:87]
    v_pk_add_f32 v[68:69], v[68:69], s[86:87]
    v_pk_add_f32 v[70:71], v[70:71], s[86:87]
    v_rcp_f32 v64, v64
    v_rcp_f32 v65, v65
    v_rcp_f32 v66, v66
    v_rcp_f32 v67, v67
    v_rcp_f32 v68, v68
    v_rcp_f32 v69, v69
    v_rcp_f32 v70, v70
    v_rcp_f32 v71, v71
    s_nop 0
    v_pk_mul_f32 v[188:189], v[188:189], v[64:65]
    v_pk_mul_f32 v[190:191], v[190:191], v[66:67]
    v_pk_mul_f32 v[204:205], v[204:205], v[68:69]
    v_pk_mul_f32 v[206:207], v[206:207], v[70:71]
    v_cvt_pk_bf16_f32 v188, v188, v189
    v_cvt_pk_bf16_f32 v189, v190, v191
    v_cvt_pk_bf16_f32 v190, v204, v205
    v_cvt_pk_bf16_f32 v191, v206, v207
    buffer_store_dwordx4 v[188:191], v22, s[48:51], s93 offen offset:1024 sc0 sc1
    ds_read_b128 v[48:51], v19 offset:256
    ds_read_b128 v[56:59], v19 offset:704
    ds_read_b128 v[52:55], v19 offset:320
    ds_read_b128 v[60:63], v19 offset:768
    s_waitcnt lgkmcnt(0)
    v_pk_fma_f32 v[64:65], v[32:33], v[48:49], v[56:57] op_sel:[1,0,0] op_sel_hi:[1,1,1] neg_lo:[1,0,0] neg_hi:[1,0,0]
    v_pk_fma_f32 v[66:67], v[32:33], v[50:51], v[58:59] op_sel:[1,0,0] op_sel_hi:[1,1,1] neg_lo:[1,0,0] neg_hi:[1,0,0]
    v_pk_fma_f32 v[68:69], v[32:33], v[52:53], v[60:61] op_sel:[1,0,0] op_sel_hi:[1,1,1] neg_lo:[1,0,0] neg_hi:[1,0,0]
    v_pk_fma_f32 v[70:71], v[32:33], v[54:55], v[62:63] op_sel:[1,0,0] op_sel_hi:[1,1,1] neg_lo:[1,0,0] neg_hi:[1,0,0]
    v_pk_fma_f32 v[208:209], v[32:33], v[208:209], v[64:65] op_sel:[0,0,0] op_sel_hi:[0,1,1]
    v_pk_fma_f32 v[210:211], v[32:33], v[210:211], v[66:67] op_sel:[0,0,0] op_sel_hi:[0,1,1]
    v_pk_fma_f32 v[224:225], v[32:33], v[224:225], v[68:69] op_sel:[0,0,0] op_sel_hi:[0,1,1]
    v_pk_fma_f32 v[226:227], v[32:33], v[226:227], v[70:71] op_sel:[0,0,0] op_sel_hi:[0,1,1]
    v_pk_mul_f32 v[64:65], v[208:209], v[208:209]
    v_pk_mul_f32 v[66:67], v[210:211], v[210:211]
    v_pk_mul_f32 v[68:69], v[224:225], v[224:225]
    v_pk_mul_f32 v[70:71], v[226:227], v[226:227]
    v_pk_fma_f32 v[64:65], v[64:65], s[84:85], v[26:27]
    v_pk_fma_f32 v[66:67], v[66:67], s[84:85], v[26:27]
    v_pk_fma_f32 v[68:69], v[68:69], s[84:85], v[26:27]
    v_pk_fma_f32 v[70:71], v[70:71], s[84:85], v[26:27]
    v_pk_mul_f32 v[64:65], v[64:65], v[208:209]
    v_pk_mul_f32 v[66:67], v[66:67], v[210:211]
    v_pk_mul_f32 v[68:69], v[68:69], v[224:225]
    v_pk_mul_f32 v[70:71], v[70:71], v[226:227]
    v_exp_f32 v64, v64
    v_exp_f32 v65, v65
    v_exp_f32 v66, v66
    v_exp_f32 v67, v67
    v_exp_f32 v68, v68
    v_exp_f32 v69, v69
    v_exp_f32 v70, v70
    v_exp_f32 v71, v71
    v_pk_mul_f32 v[208:209], v[34:35], v[208:209] op_sel:[0,0] op_sel_hi:[0,1]
    v_pk_mul_f32 v[210:211], v[34:35], v[210:211] op_sel:[0,0] op_sel_hi:[0,1]
    v_pk_mul_f32 v[224:225], v[34:35], v[224:225] op_sel:[0,0] op_sel_hi:[0,1]
    v_pk_mul_f32 v[226:227], v[34:35], v[226:227] op_sel:[0,0] op_sel_hi:[0,1]
    v_pk_add_f32 v[64:65], v[64:65], s[86:87]
    v_pk_add_f32 v[66:67], v[66:67], s[86:87]
    v_pk_add_f32 v[68:69], v[68:69], s[86:87]
    v_pk_add_f32 v[70:71], v[70:71], s[86:87]
    v_rcp_f32 v64, v64
    v_rcp_f32 v65, v65
    v_rcp_f32 v66, v66
    v_rcp_f32 v67, v67
    v_rcp_f32 v68, v68
    v_rcp_f32 v69, v69
    v_rcp_f32 v70, v70
    v_rcp_f32 v71, v71
    s_nop 0
    v_pk_mul_f32 v[208:209], v[208:209], v[64:65]
    v_pk_mul_f32 v[210:211], v[210:211], v[66:67]
    v_pk_mul_f32 v[224:225], v[224:225], v[68:69]
    v_pk_mul_f32 v[226:227], v[226:227], v[70:71]
    v_cvt_pk_bf16_f32 v208, v208, v209
    v_cvt_pk_bf16_f32 v209, v210, v211
    v_cvt_pk_bf16_f32 v210, v224, v225
    v_cvt_pk_bf16_f32 v211, v226, v227
    buffer_store_dwordx4 v[208:211], v22, s[48:51], s90 offen offset:2048 sc0 sc1
    v_pk_fma_f32 v[64:65], v[36:37], v[48:49], v[56:57] op_sel:[1,0,0] op_sel_hi:[1,1,1] neg_lo:[1,0,0] neg_hi:[1,0,0]
    v_pk_fma_f32 v[66:67], v[36:37], v[50:51], v[58:59] op_sel:[1,0,0] op_sel_hi:[1,1,1] neg_lo:[1,0,0] neg_hi:[1,0,0]
    v_pk_fma_f32 v[68:69], v[36:37], v[52:53], v[60:61] op_sel:[1,0,0] op_sel_hi:[1,1,1] neg_lo:[1,0,0] neg_hi:[1,0,0]
    v_pk_fma_f32 v[70:71], v[36:37], v[54:55], v[62:63] op_sel:[1,0,0] op_sel_hi:[1,1,1] neg_lo:[1,0,0] neg_hi:[1,0,0]
    v_pk_fma_f32 v[212:213], v[36:37], v[212:213], v[64:65] op_sel:[0,0,0] op_sel_hi:[0,1,1]
    v_pk_fma_f32 v[214:215], v[36:37], v[214:215], v[66:67] op_sel:[0,0,0] op_sel_hi:[0,1,1]
    v_pk_fma_f32 v[228:229], v[36:37], v[228:229], v[68:69] op_sel:[0,0,0] op_sel_hi:[0,1,1]
    v_pk_fma_f32 v[230:231], v[36:37], v[230:231], v[70:71] op_sel:[0,0,0] op_sel_hi:[0,1,1]
    v_pk_mul_f32 v[64:65], v[212:213], v[212:213]
    v_pk_mul_f32 v[66:67], v[214:215], v[214:215]
    v_pk_mul_f32 v[68:69], v[228:229], v[228:229]
    v_pk_mul_f32 v[70:71], v[230:231], v[230:231]
    v_pk_fma_f32 v[64:65], v[64:65], s[84:85], v[26:27]
    v_pk_fma_f32 v[66:67], v[66:67], s[84:85], v[26:27]
    v_pk_fma_f32 v[68:69], v[68:69], s[84:85], v[26:27]
    v_pk_fma_f32 v[70:71], v[70:71], s[84:85], v[26:27]
    v_pk_mul_f32 v[64:65], v[64:65], v[212:213]
    v_pk_mul_f32 v[66:67], v[66:67], v[214:215]
    v_pk_mul_f32 v[68:69], v[68:69], v[228:229]
    v_pk_mul_f32 v[70:71], v[70:71], v[230:231]
    v_exp_f32 v64, v64
    v_exp_f32 v65, v65
    v_exp_f32 v66, v66
    v_exp_f32 v67, v67
    v_exp_f32 v68, v68
    v_exp_f32 v69, v69
    v_exp_f32 v70, v70
    v_exp_f32 v71, v71
    v_pk_mul_f32 v[212:213], v[38:39], v[212:213] op_sel:[0,0] op_sel_hi:[0,1]
    v_pk_mul_f32 v[214:215], v[38:39], v[214:215] op_sel:[0,0] op_sel_hi:[0,1]
    v_pk_mul_f32 v[228:229], v[38:39], v[228:229] op_sel:[0,0] op_sel_hi:[0,1]
    v_pk_mul_f32 v[230:231], v[38:39], v[230:231] op_sel:[0,0] op_sel_hi:[0,1]
    v_pk_add_f32 v[64:65], v[64:65], s[86:87]
    v_pk_add_f32 v[66:67], v[66:67], s[86:87]
    v_pk_add_f32 v[68:69], v[68:69], s[86:87]
    v_pk_add_f32 v[70:71], v[70:71], s[86:87]
    v_rcp_f32 v64, v64
    v_rcp_f32 v65, v65
    v_rcp_f32 v66, v66
    v_rcp_f32 v67, v67
    v_rcp_f32 v68, v68
    v_rcp_f32 v69, v69
    v_rcp_f32 v70, v70
    v_rcp_f32 v71, v71
    s_nop 0
    v_pk_mul_f32 v[212:213], v[212:213], v[64:65]
    v_pk_mul_f32 v[214:215], v[214:215], v[66:67]
    v_pk_mul_f32 v[228:229], v[228:229], v[68:69]
    v_pk_mul_f32 v[230:231], v[230:231], v[70:71]
    v_cvt_pk_bf16_f32 v212, v212, v213
    v_cvt_pk_bf16_f32 v213, v214, v215
    v_cvt_pk_bf16_f32 v214, v228, v229
    v_cvt_pk_bf16_f32 v215, v230, v231
    buffer_store_dwordx4 v[212:215], v22, s[48:51], s91 offen offset:2048 sc0 sc1
    v_pk_fma_f32 v[64:65], v[40:41], v[48:49], v[56:57] op_sel:[1,0,0] op_sel_hi:[1,1,1] neg_lo:[1,0,0] neg_hi:[1,0,0]
    v_pk_fma_f32 v[66:67], v[40:41], v[50:51], v[58:59] op_sel:[1,0,0] op_sel_hi:[1,1,1] neg_lo:[1,0,0] neg_hi:[1,0,0]
    v_pk_fma_f32 v[68:69], v[40:41], v[52:53], v[60:61] op_sel:[1,0,0] op_sel_hi:[1,1,1] neg_lo:[1,0,0] neg_hi:[1,0,0]
    v_pk_fma_f32 v[70:71], v[40:41], v[54:55], v[62:63] op_sel:[1,0,0] op_sel_hi:[1,1,1] neg_lo:[1,0,0] neg_hi:[1,0,0]
    v_pk_fma_f32 v[216:217], v[40:41], v[216:217], v[64:65] op_sel:[0,0,0] op_sel_hi:[0,1,1]
    v_pk_fma_f32 v[218:219], v[40:41], v[218:219], v[66:67] op_sel:[0,0,0] op_sel_hi:[0,1,1]
    v_pk_fma_f32 v[232:233], v[40:41], v[232:233], v[68:69] op_sel:[0,0,0] op_sel_hi:[0,1,1]
    v_pk_fma_f32 v[234:235], v[40:41], v[234:235], v[70:71] op_sel:[0,0,0] op_sel_hi:[0,1,1]
    v_pk_mul_f32 v[64:65], v[216:217], v[216:217]
    v_pk_mul_f32 v[66:67], v[218:219], v[218:219]
    v_pk_mul_f32 v[68:69], v[232:233], v[232:233]
    v_pk_mul_f32 v[70:71], v[234:235], v[234:235]
    v_pk_fma_f32 v[64:65], v[64:65], s[84:85], v[26:27]
    v_pk_fma_f32 v[66:67], v[66:67], s[84:85], v[26:27]
    v_pk_fma_f32 v[68:69], v[68:69], s[84:85], v[26:27]
    v_pk_fma_f32 v[70:71], v[70:71], s[84:85], v[26:27]
    v_pk_mul_f32 v[64:65], v[64:65], v[216:217]
    v_pk_mul_f32 v[66:67], v[66:67], v[218:219]
    v_pk_mul_f32 v[68:69], v[68:69], v[232:233]
    v_pk_mul_f32 v[70:71], v[70:71], v[234:235]
    v_exp_f32 v64, v64
    v_exp_f32 v65, v65
    v_exp_f32 v66, v66
    v_exp_f32 v67, v67
    v_exp_f32 v68, v68
    v_exp_f32 v69, v69
    v_exp_f32 v70, v70
    v_exp_f32 v71, v71
    v_pk_mul_f32 v[216:217], v[42:43], v[216:217] op_sel:[0,0] op_sel_hi:[0,1]
    v_pk_mul_f32 v[218:219], v[42:43], v[218:219] op_sel:[0,0] op_sel_hi:[0,1]
    v_pk_mul_f32 v[232:233], v[42:43], v[232:233] op_sel:[0,0] op_sel_hi:[0,1]
    v_pk_mul_f32 v[234:235], v[42:43], v[234:235] op_sel:[0,0] op_sel_hi:[0,1]
    v_pk_add_f32 v[64:65], v[64:65], s[86:87]
    v_pk_add_f32 v[66:67], v[66:67], s[86:87]
    v_pk_add_f32 v[68:69], v[68:69], s[86:87]
    v_pk_add_f32 v[70:71], v[70:71], s[86:87]
    v_rcp_f32 v64, v64
    v_rcp_f32 v65, v65
    v_rcp_f32 v66, v66
    v_rcp_f32 v67, v67
    v_rcp_f32 v68, v68
    v_rcp_f32 v69, v69
    v_rcp_f32 v70, v70
    v_rcp_f32 v71, v71
    s_nop 0
    v_pk_mul_f32 v[216:217], v[216:217], v[64:65]
    v_pk_mul_f32 v[218:219], v[218:219], v[66:67]
    v_pk_mul_f32 v[232:233], v[232:233], v[68:69]
    v_pk_mul_f32 v[234:235], v[234:235], v[70:71]
    v_cvt_pk_bf16_f32 v216, v216, v217
    v_cvt_pk_bf16_f32 v217, v218, v219
    v_cvt_pk_bf16_f32 v218, v232, v233
    v_cvt_pk_bf16_f32 v219, v234, v235
    buffer_store_dwordx4 v[216:219], v22, s[48:51], s92 offen offset:2048 sc0 sc1
    v_pk_fma_f32 v[64:65], v[44:45], v[48:49], v[56:57] op_sel:[1,0,0] op_sel_hi:[1,1,1] neg_lo:[1,0,0] neg_hi:[1,0,0]
    v_pk_fma_f32 v[66:67], v[44:45], v[50:51], v[58:59] op_sel:[1,0,0] op_sel_hi:[1,1,1] neg_lo:[1,0,0] neg_hi:[1,0,0]
    v_pk_fma_f32 v[68:69], v[44:45], v[52:53], v[60:61] op_sel:[1,0,0] op_sel_hi:[1,1,1] neg_lo:[1,0,0] neg_hi:[1,0,0]
    v_pk_fma_f32 v[70:71], v[44:45], v[54:55], v[62:63] op_sel:[1,0,0] op_sel_hi:[1,1,1] neg_lo:[1,0,0] neg_hi:[1,0,0]
    v_pk_fma_f32 v[220:221], v[44:45], v[220:221], v[64:65] op_sel:[0,0,0] op_sel_hi:[0,1,1]
    v_pk_fma_f32 v[222:223], v[44:45], v[222:223], v[66:67] op_sel:[0,0,0] op_sel_hi:[0,1,1]
    v_pk_fma_f32 v[236:237], v[44:45], v[236:237], v[68:69] op_sel:[0,0,0] op_sel_hi:[0,1,1]
    v_pk_fma_f32 v[238:239], v[44:45], v[238:239], v[70:71] op_sel:[0,0,0] op_sel_hi:[0,1,1]
    v_pk_mul_f32 v[64:65], v[220:221], v[220:221]
    v_pk_mul_f32 v[66:67], v[222:223], v[222:223]
    v_pk_mul_f32 v[68:69], v[236:237], v[236:237]
    v_pk_mul_f32 v[70:71], v[238:239], v[238:239]
    v_pk_fma_f32 v[64:65], v[64:65], s[84:85], v[26:27]
    v_pk_fma_f32 v[66:67], v[66:67], s[84:85], v[26:27]
    v_pk_fma_f32 v[68:69], v[68:69], s[84:85], v[26:27]
    v_pk_fma_f32 v[70:71], v[70:71], s[84:85], v[26:27]
    v_pk_mul_f32 v[64:65], v[64:65], v[220:221]
    v_pk_mul_f32 v[66:67], v[66:67], v[222:223]
    v_pk_mul_f32 v[68:69], v[68:69], v[236:237]
    v_pk_mul_f32 v[70:71], v[70:71], v[238:239]
    v_exp_f32 v64, v64
    v_exp_f32 v65, v65
    v_exp_f32 v66, v66
    v_exp_f32 v67, v67
    v_exp_f32 v68, v68
    v_exp_f32 v69, v69
    v_exp_f32 v70, v70
    v_exp_f32 v71, v71
    v_pk_mul_f32 v[220:221], v[46:47], v[220:221] op_sel:[0,0] op_sel_hi:[0,1]
    v_pk_mul_f32 v[222:223], v[46:47], v[222:223] op_sel:[0,0] op_sel_hi:[0,1]
    v_pk_mul_f32 v[236:237], v[46:47], v[236:237] op_sel:[0,0] op_sel_hi:[0,1]
    v_pk_mul_f32 v[238:239], v[46:47], v[238:239] op_sel:[0,0] op_sel_hi:[0,1]
    v_pk_add_f32 v[64:65], v[64:65], s[86:87]
    v_pk_add_f32 v[66:67], v[66:67], s[86:87]
    v_pk_add_f32 v[68:69], v[68:69], s[86:87]
    v_pk_add_f32 v[70:71], v[70:71], s[86:87]
    v_rcp_f32 v64, v64
    v_rcp_f32 v65, v65
    v_rcp_f32 v66, v66
    v_rcp_f32 v67, v67
    v_rcp_f32 v68, v68
    v_rcp_f32 v69, v69
    v_rcp_f32 v70, v70
    v_rcp_f32 v71, v71
    s_nop 0
    v_pk_mul_f32 v[220:221], v[220:221], v[64:65]
    v_pk_mul_f32 v[222:223], v[222:223], v[66:67]
    v_pk_mul_f32 v[236:237], v[236:237], v[68:69]
    v_pk_mul_f32 v[238:239], v[238:239], v[70:71]
    v_cvt_pk_bf16_f32 v220, v220, v221
    v_cvt_pk_bf16_f32 v221, v222, v223
    v_cvt_pk_bf16_f32 v222, v236, v237
    v_cvt_pk_bf16_f32 v223, v238, v239
    buffer_store_dwordx4 v[220:223], v22, s[48:51], s93 offen offset:2048 sc0 sc1
    ds_read_b128 v[48:51], v19 offset:384
    ds_read_b128 v[56:59], v19 offset:832
    s_waitcnt lgkmcnt(0)
    v_pk_fma_f32 v[64:65], v[32:33], v[48:49], v[56:57] op_sel:[1,0,0] op_sel_hi:[1,1,1] neg_lo:[1,0,0] neg_hi:[1,0,0]
    v_pk_fma_f32 v[66:67], v[32:33], v[50:51], v[58:59] op_sel:[1,0,0] op_sel_hi:[1,1,1] neg_lo:[1,0,0] neg_hi:[1,0,0]
    v_pk_fma_f32 v[240:241], v[32:33], v[240:241], v[64:65] op_sel:[0,0,0] op_sel_hi:[0,1,1]
    v_pk_fma_f32 v[242:243], v[32:33], v[242:243], v[66:67] op_sel:[0,0,0] op_sel_hi:[0,1,1]
    v_pk_mul_f32 v[64:65], v[240:241], v[240:241]
    v_pk_mul_f32 v[66:67], v[242:243], v[242:243]
    v_pk_fma_f32 v[64:65], v[64:65], s[84:85], v[26:27]
    v_pk_fma_f32 v[66:67], v[66:67], s[84:85], v[26:27]
    v_pk_mul_f32 v[64:65], v[64:65], v[240:241]
    v_pk_mul_f32 v[66:67], v[66:67], v[242:243]
    v_exp_f32 v64, v64
    v_exp_f32 v65, v65
    v_exp_f32 v66, v66
    v_exp_f32 v67, v67
    v_pk_mul_f32 v[240:241], v[34:35], v[240:241] op_sel:[0,0] op_sel_hi:[0,1]
    v_pk_mul_f32 v[242:243], v[34:35], v[242:243] op_sel:[0,0] op_sel_hi:[0,1]
    v_pk_add_f32 v[64:65], v[64:65], s[86:87]
    v_pk_add_f32 v[66:67], v[66:67], s[86:87]
    v_rcp_f32 v64, v64
    v_rcp_f32 v65, v65
    v_rcp_f32 v66, v66
    v_rcp_f32 v67, v67
    s_nop 0
    v_pk_mul_f32 v[240:241], v[240:241], v[64:65]
    v_pk_mul_f32 v[242:243], v[242:243], v[66:67]
    v_cvt_pk_bf16_f32 v240, v240, v241
    v_cvt_pk_bf16_f32 v241, v242, v243
    buffer_store_dwordx2 v[240:241], v23, s[48:51], s90 offen sc0 sc1
    v_pk_fma_f32 v[64:65], v[36:37], v[48:49], v[56:57] op_sel:[1,0,0] op_sel_hi:[1,1,1] neg_lo:[1,0,0] neg_hi:[1,0,0]
    v_pk_fma_f32 v[66:67], v[36:37], v[50:51], v[58:59] op_sel:[1,0,0] op_sel_hi:[1,1,1] neg_lo:[1,0,0] neg_hi:[1,0,0]
    v_pk_fma_f32 v[244:245], v[36:37], v[244:245], v[64:65] op_sel:[0,0,0] op_sel_hi:[0,1,1]
    v_pk_fma_f32 v[246:247], v[36:37], v[246:247], v[66:67] op_sel:[0,0,0] op_sel_hi:[0,1,1]
    v_pk_mul_f32 v[64:65], v[244:245], v[244:245]
    v_pk_mul_f32 v[66:67], v[246:247], v[246:247]
    v_pk_fma_f32 v[64:65], v[64:65], s[84:85], v[26:27]
    v_pk_fma_f32 v[66:67], v[66:67], s[84:85], v[26:27]
    v_pk_mul_f32 v[64:65], v[64:65], v[244:245]
    v_pk_mul_f32 v[66:67], v[66:67], v[246:247]
    v_exp_f32 v64, v64
    v_exp_f32 v65, v65
    v_exp_f32 v66, v66
    v_exp_f32 v67, v67
    v_pk_mul_f32 v[244:245], v[38:39], v[244:245] op_sel:[0,0] op_sel_hi:[0,1]
    v_pk_mul_f32 v[246:247], v[38:39], v[246:247] op_sel:[0,0] op_sel_hi:[0,1]
    v_pk_add_f32 v[64:65], v[64:65], s[86:87]
    v_pk_add_f32 v[66:67], v[66:67], s[86:87]
    v_rcp_f32 v64, v64
    v_rcp_f32 v65, v65
    v_rcp_f32 v66, v66
    v_rcp_f32 v67, v67
    s_nop 0
    v_pk_mul_f32 v[244:245], v[244:245], v[64:65]
    v_pk_mul_f32 v[246:247], v[246:247], v[66:67]
    v_cvt_pk_bf16_f32 v244, v244, v245
    v_cvt_pk_bf16_f32 v245, v246, v247
    buffer_store_dwordx2 v[244:245], v23, s[48:51], s91 offen sc0 sc1
    v_pk_fma_f32 v[64:65], v[40:41], v[48:49], v[56:57] op_sel:[1,0,0] op_sel_hi:[1,1,1] neg_lo:[1,0,0] neg_hi:[1,0,0]
    v_pk_fma_f32 v[66:67], v[40:41], v[50:51], v[58:59] op_sel:[1,0,0] op_sel_hi:[1,1,1] neg_lo:[1,0,0] neg_hi:[1,0,0]
    v_pk_fma_f32 v[248:249], v[40:41], v[248:249], v[64:65] op_sel:[0,0,0] op_sel_hi:[0,1,1]
    v_pk_fma_f32 v[250:251], v[40:41], v[250:251], v[66:67] op_sel:[0,0,0] op_sel_hi:[0,1,1]
    v_pk_mul_f32 v[64:65], v[248:249], v[248:249]
    v_pk_mul_f32 v[66:67], v[250:251], v[250:251]
    v_pk_fma_f32 v[64:65], v[64:65], s[84:85], v[26:27]
    v_pk_fma_f32 v[66:67], v[66:67], s[84:85], v[26:27]
    v_pk_mul_f32 v[64:65], v[64:65], v[248:249]
    v_pk_mul_f32 v[66:67], v[66:67], v[250:251]
    v_exp_f32 v64, v64
    v_exp_f32 v65, v65
    v_exp_f32 v66, v66
    v_exp_f32 v67, v67
    v_pk_mul_f32 v[248:249], v[42:43], v[248:249] op_sel:[0,0] op_sel_hi:[0,1]
    v_pk_mul_f32 v[250:251], v[42:43], v[250:251] op_sel:[0,0] op_sel_hi:[0,1]
    v_pk_add_f32 v[64:65], v[64:65], s[86:87]
    v_pk_add_f32 v[66:67], v[66:67], s[86:87]
    v_rcp_f32 v64, v64
    v_rcp_f32 v65, v65
    v_rcp_f32 v66, v66
    v_rcp_f32 v67, v67
    s_nop 0
    v_pk_mul_f32 v[248:249], v[248:249], v[64:65]
    v_pk_mul_f32 v[250:251], v[250:251], v[66:67]
    v_cvt_pk_bf16_f32 v248, v248, v249
    v_cvt_pk_bf16_f32 v249, v250, v251
    buffer_store_dwordx2 v[248:249], v23, s[48:51], s92 offen sc0 sc1
    v_pk_fma_f32 v[64:65], v[44:45], v[48:49], v[56:57] op_sel:[1,0,0] op_sel_hi:[1,1,1] neg_lo:[1,0,0] neg_hi:[1,0,0]
    v_pk_fma_f32 v[66:67], v[44:45], v[50:51], v[58:59] op_sel:[1,0,0] op_sel_hi:[1,1,1] neg_lo:[1,0,0] neg_hi:[1,0,0]
    v_pk_fma_f32 v[252:253], v[44:45], v[252:253], v[64:65] op_sel:[0,0,0] op_sel_hi:[0,1,1]
    v_pk_fma_f32 v[254:255], v[44:45], v[254:255], v[66:67] op_sel:[0,0,0] op_sel_hi:[0,1,1]
    v_pk_mul_f32 v[64:65], v[252:253], v[252:253]
    v_pk_mul_f32 v[66:67], v[254:255], v[254:255]
    v_pk_fma_f32 v[64:65], v[64:65], s[84:85], v[26:27]
    v_pk_fma_f32 v[66:67], v[66:67], s[84:85], v[26:27]
    v_pk_mul_f32 v[64:65], v[64:65], v[252:253]
    v_pk_mul_f32 v[66:67], v[66:67], v[254:255]
    v_exp_f32 v64, v64
    v_exp_f32 v65, v65
    v_exp_f32 v66, v66
    v_exp_f32 v67, v67
    v_pk_mul_f32 v[252:253], v[46:47], v[252:253] op_sel:[0,0] op_sel_hi:[0,1]
    v_pk_mul_f32 v[254:255], v[46:47], v[254:255] op_sel:[0,0] op_sel_hi:[0,1]
    v_pk_add_f32 v[64:65], v[64:65], s[86:87]
    v_pk_add_f32 v[66:67], v[66:67], s[86:87]
    v_rcp_f32 v64, v64
    v_rcp_f32 v65, v65
    v_rcp_f32 v66, v66
    v_rcp_f32 v67, v67
    s_nop 0
    v_pk_mul_f32 v[252:253], v[252:253], v[64:65]
    v_pk_mul_f32 v[254:255], v[254:255], v[66:67]
    v_cvt_pk_bf16_f32 v252, v252, v253
    v_cvt_pk_bf16_f32 v253, v254, v255
    buffer_store_dwordx2 v[252:253], v23, s[48:51], s93 offen sc0 sc1
    s_lshl_b32 s71, s68, 8
    v_lshlrev_b32 v18, 4, v3
    v_add_u32 v18, s71, v18
    v_add_u32 v18, 160768, v18
    ds_read_b128 v[32:35], v18 offset:0
    ds_read_b128 v[36:39], v18 offset:64
    ds_read_b128 v[40:43], v18 offset:128
    ds_read_b128 v[44:47], v18 offset:192
    v_mul_f32 v48, v4, v4
    v_fma_f32 v48, -v5, v5, v48
    v_mul_f32 v49, v4, v5
    v_add_f32 v49, v49, v49
    v_mul_f32 v50, v8, v8
    v_fma_f32 v50, -v9, v9, v50
    v_mul_f32 v51, v8, v9
    v_add_f32 v51, v51, v51
    s_lshl_b32 s71, s68, 13
    s_add_u32 s71, s71, 114688
    v_lshlrev_b32 v25, 5, v2
    v_lshlrev_b32 v28, 3, v3
    v_add_u32 v25, v25, v28
    v_add_u32 v25, s71, v25
    v_lshrrev_b32 v28, 2, v1
    v_and_b32 v28, 3, v28
    v_lshlrev_b32 v29, 3, v3
    v_add_u32 v28, v28, v29
    v_lshlrev_b32 v28, 5, v28
    v_and_b32 v29, 3, v1
    v_lshlrev_b32 v29, 3, v29
    v_add_u32 v28, v28, v29
    v_add_u32 v28, s71, v28
    s_barrier
    v_add_u32 v20, 4096, v20
    ds_read_b32 v52, v20 offset:0
    ds_read_b32 v53, v20 offset:128
    ds_read_b32 v54, v20 offset:64
    ds_read_b32 v55, v20 offset:192
    s_waitcnt lgkmcnt(0)
    v_mul_f32 v64, v6, v52
    v_fma_f32 v64, -v7, v53, v64
    v_mul_f32 v65, v6, v53
    v_fmac_f32 v65, v7, v52
    v_mul_f32 v56, v4, v64
    v_fma_f32 v56, -v5, v65, v56
    v_mul_f32 v60, v4, v65
    v_fmac_f32 v60, v5, v64
    v_mul_f32 v57, v4, v56
    v_fma_f32 v57, -v5, v60, v57
    v_mul_f32 v61, v4, v60
    v_fmac_f32 v61, v5, v56
    v_mul_f32 v64, v10, v54
    v_fma_f32 v64, -v11, v55, v64
    v_mul_f32 v65, v10, v55
    v_fmac_f32 v65, v11, v54
    v_mul_f32 v58, v8, v64
    v_fma_f32 v58, -v9, v65, v58
    v_mul_f32 v62, v8, v65
    v_fmac_f32 v62, v9, v64
    v_mul_f32 v59, v8, v58
    v_fma_f32 v59, -v9, v62, v59
    v_mul_f32 v63, v8, v62
    v_fmac_f32 v63, v9, v58
    v_pk_fma_f32 v[64:65], v[6:7], v[80:81], v[56:57] op_sel:[0,0,0] op_sel_hi:[0,1,1]
    v_pk_fma_f32 v[66:67], v[6:7], v[112:113], v[60:61] op_sel:[0,0,0] op_sel_hi:[0,1,1]
    v_pk_fma_f32 v[64:65], v[6:7], v[112:113], v[64:65] op_sel:[1,0,0] op_sel_hi:[1,1,1] neg_lo:[1,0,0] neg_hi:[1,0,0]
    v_pk_fma_f32 v[66:67], v[6:7], v[80:81], v[66:67] op_sel:[1,0,0] op_sel_hi:[1,1,1]
    v_pk_mul_f32 v[72:73], v[48:49], v[56:57] op_sel:[0,0] op_sel_hi:[0,1]
    v_pk_mul_f32 v[74:75], v[48:49], v[60:61] op_sel:[0,0] op_sel_hi:[0,1]
    v_pk_fma_f32 v[72:73], v[48:49], v[60:61], v[72:73] op_sel:[1,0,0] op_sel_hi:[1,1,1] neg_lo:[1,0,0] neg_hi:[1,0,0]
    v_pk_fma_f32 v[60:61], v[48:49], v[56:57], v[74:75] op_sel:[1,0,0] op_sel_hi:[1,1,1]
    v_mov_b32 v56, v72
    v_mov_b32 v57, v73
    v_pk_mul_f32 v[64:65], v[64:65], v[32:33]
    v_pk_mul_f32 v[66:67], v[66:67], v[32:33] neg_lo:[1,0] neg_hi:[1,0]
    v_cvt_pk_bf16_f32 v80, v64, v65
    v_cvt_pk_bf16_f32 v112, v66, v67
    v_pk_fma_f32 v[68:69], v[10:11], v[96:97], v[58:59] op_sel:[0,0,0] op_sel_hi:[0,1,1]
    v_pk_fma_f32 v[70:71], v[10:11], v[128:129], v[62:63] op_sel:[0,0,0] op_sel_hi:[0,1,1]
    v_pk_fma_f32 v[68:69], v[10:11], v[128:129], v[68:69] op_sel:[1,0,0] op_sel_hi:[1,1,1] neg_lo:[1,0,0] neg_hi:[1,0,0]
    v_pk_fma_f32 v[70:71], v[10:11], v[96:97], v[70:71] op_sel:[1,0,0] op_sel_hi:[1,1,1]
    v_pk_mul_f32 v[76:77], v[50:51], v[58:59] op_sel:[0,0] op_sel_hi:[0,1]
    v_pk_mul_f32 v[78:79], v[50:51], v[62:63] op_sel:[0,0] op_sel_hi:[0,1]
    v_pk_fma_f32 v[76:77], v[50:51], v[62:63], v[76:77] op_sel:[1,0,0] op_sel_hi:[1,1,1] neg_lo:[1,0,0] neg_hi:[1,0,0]
    v_pk_fma_f32 v[62:63], v[50:51], v[58:59], v[78:79] op_sel:[1,0,0] op_sel_hi:[1,1,1]
    v_mov_b32 v58, v76
    v_mov_b32 v59, v77
    v_pk_mul_f32 v[68:69], v[68:69], v[32:33]
    v_pk_mul_f32 v[70:71], v[70:71], v[32:33] neg_lo:[1,0] neg_hi:[1,0]
    v_cvt_pk_bf16_f32 v96, v68, v69
    v_cvt_pk_bf16_f32 v128, v70, v71
    v_pk_fma_f32 v[64:65], v[6:7], v[82:83], v[56:57] op_sel:[0,0,0] op_sel_hi:[0,1,1]
    v_pk_fma_f32 v[66:67], v[6:7], v[114:115], v[60:61] op_sel:[0,0,0] op_sel_hi:[0,1,1]
    v_pk_fma_f32 v[64:65], v[6:7], v[114:115], v[64:65] op_sel:[1,0,0] op_sel_hi:[1,1,1] neg_lo:[1,0,0] neg_hi:[1,0,0]
    v_pk_fma_f32 v[66:67], v[6:7], v[82:83], v[66:67] op_sel:[1,0,0] op_sel_hi:[1,1,1]
    v_pk_mul_f32 v[72:73], v[48:49], v[56:57] op_sel:[0,0] op_sel_hi:[0,1]
    v_pk_mul_f32 v[74:75], v[48:49], v[60:61] op_sel:[0,0] op_sel_hi:[0,1]
    v_pk_fma_f32 v[72:73], v[48:49], v[60:61], v[72:73] op_sel:[1,0,0] op_sel_hi:[1,1,1] neg_lo:[1,0,0] neg_hi:[1,0,0]
    v_pk_fma_f32 v[60:61], v[48:49], v[56:57], v[74:75] op_sel:[1,0,0] op_sel_hi:[1,1,1]
    v_mov_b32 v56, v72
    v_mov_b32 v57, v73
    v_pk_mul_f32 v[64:65], v[64:65], v[34:35]
    v_pk_mul_f32 v[66:67], v[66:67], v[34:35] neg_lo:[1,0] neg_hi:[1,0]
    v_cvt_pk_bf16_f32 v81, v64, v65
    v_cvt_pk_bf16_f32 v113, v66, v67
    v_pk_fma_f32 v[68:69], v[10:11], v[98:99], v[58:59] op_sel:[0,0,0] op_sel_hi:[0,1,1]
    v_pk_fma_f32 v[70:71], v[10:11], v[130:131], v[62:63] op_sel:[0,0,0] op_sel_hi:[0,1,1]
    v_pk_fma_f32 v[68:69], v[10:11], v[130:131], v[68:69] op_sel:[1,0,0] op_sel_hi:[1,1,1] neg_lo:[1,0,0] neg_hi:[1,0,0]
    v_pk_fma_f32 v[70:71], v[10:11], v[98:99], v[70:71] op_sel:[1,0,0] op_sel_hi:[1,1,1]
    v_pk_mul_f32 v[76:77], v[50:51], v[58:59] op_sel:[0,0] op_sel_hi:[0,1]
    v_pk_mul_f32 v[78:79], v[50:51], v[62:63] op_sel:[0,0] op_sel_hi:[0,1]
    v_pk_fma_f32 v[76:77], v[50:51], v[62:63], v[76:77] op_sel:[1,0,0] op_sel_hi:[1,1,1] neg_lo:[1,0,0] neg_hi:[1,0,0]
    v_pk_fma_f32 v[62:63], v[50:51], v[58:59], v[78:79] op_sel:[1,0,0] op_sel_hi:[1,1,1]
    v_mov_b32 v58, v76
    v_mov_b32 v59, v77
    v_pk_mul_f32 v[68:69], v[68:69], v[34:35]
    v_pk_mul_f32 v[70:71], v[70:71], v[34:35] neg_lo:[1,0] neg_hi:[1,0]
    v_cvt_pk_bf16_f32 v97, v68, v69
    v_cvt_pk_bf16_f32 v129, v70, v71
    ds_write_b64 v25, v[80:81] offset:0
    ds_write_b64 v25, v[96:97] offset:512
    ds_write_b64 v25, v[112:113] offset:1024
    ds_write_b64 v25, v[128:129] offset:1536
    v_pk_fma_f32 v[64:65], v[6:7], v[84:85], v[56:57] op_sel:[0,0,0] op_sel_hi:[0,1,1]
    v_pk_fma_f32 v[66:67], v[6:7], v[116:117], v[60:61] op_sel:[0,0,0] op_sel_hi:[0,1,1]
    v_pk_fma_f32 v[64:65], v[6:7], v[116:117], v[64:65] op_sel:[1,0,0] op_sel_hi:[1,1,1] neg_lo:[1,0,0] neg_hi:[1,0,0]
    v_pk_fma_f32 v[66:67], v[6:7], v[84:85], v[66:67] op_sel:[1,0,0] op_sel_hi:[1,1,1]
    v_pk_mul_f32 v[72:73], v[48:49], v[56:57] op_sel:[0,0] op_sel_hi:[0,1]
    v_pk_mul_f32 v[74:75], v[48:49], v[60:61] op_sel:[0,0] op_sel_hi:[0,1]
    v_pk_fma_f32 v[72:73], v[48:49], v[60:61], v[72:73] op_sel:[1,0,0] op_sel_hi:[1,1,1] neg_lo:[1,0,0] neg_hi:[1,0,0]
    v_pk_fma_f32 v[60:61], v[48:49], v[56:57], v[74:75] op_sel:[1,0,0] op_sel_hi:[1,1,1]
    v_mov_b32 v56, v72
    v_mov_b32 v57, v73
    v_pk_mul_f32 v[64:65], v[64:65], v[36:37]
    v_pk_mul_f32 v[66:67], v[66:67], v[36:37] neg_lo:[1,0] neg_hi:[1,0]
    v_cvt_pk_bf16_f32 v84, v64, v65
    v_cvt_pk_bf16_f32 v116, v66, v67
    v_pk_fma_f32 v[68:69], v[10:11], v[100:101], v[58:59] op_sel:[0,0,0] op_sel_hi:[0,1,1]
    v_pk_fma_f32 v[70:71], v[10:11], v[132:133], v[62:63] op_sel:[0,0,0] op_sel_hi:[0,1,1]
    v_pk_fma_f32 v[68:69], v[10:11], v[132:133], v[68:69] op_sel:[1,0,0] op_sel_hi:[1,1,1] neg_lo:[1,0,0] neg_hi:[1,0,0]
    v_pk_fma_f32 v[70:71], v[10:11], v[100:101], v[70:71] op_sel:[1,0,0] op_sel_hi:[1,1,1]
    v_pk_mul_f32 v[76:77], v[50:51], v[58:59] op_sel:[0,0] op_sel_hi:[0,1]
    v_pk_mul_f32 v[78:79], v[50:51], v[62:63] op_sel:[0,0] op_sel_hi:[0,1]
    v_pk_fma_f32 v[76:77], v[50:51], v[62:63], v[76:77] op_sel:[1,0,0] op_sel_hi:[1,1,1] neg_lo:[1,0,0] neg_hi:[1,0,0]
    v_pk_fma_f32 v[62:63], v[50:51], v[58:59], v[78:79] op_sel:[1,0,0] op_sel_hi:[1,1,1]
    v_mov_b32 v58, v76
    v_mov_b32 v59, v77
    v_pk_mul_f32 v[68:69], v[68:69], v[36:37]
    v_pk_mul_f32 v[70:71], v[70:71], v[36:37] neg_lo:[1,0] neg_hi:[1,0]
    v_cvt_pk_bf16_f32 v100, v68, v69
    v_cvt_pk_bf16_f32 v132, v70, v71
    v_pk_fma_f32 v[64:65], v[6:7], v[86:87], v[56:57] op_sel:[0,0,0] op_sel_hi:[0,1,1]
    v_pk_fma_f32 v[66:67], v[6:7], v[118:119], v[60:61] op_sel:[0,0,0] op_sel_hi:[0,1,1]
    v_pk_fma_f32 v[64:65], v[6:7], v[118:119], v[64:65] op_sel:[1,0,0] op_sel_hi:[1,1,1] neg_lo:[1,0,0] neg_hi:[1,0,0]
    v_pk_fma_f32 v[66:67], v[6:7], v[86:87], v[66:67] op_sel:[1,0,0] op_sel_hi:[1,1,1]
    v_pk_mul_f32 v[72:73], v[48:49], v[56:57] op_sel:[0,0] op_sel_hi:[0,1]
    v_pk_mul_f32 v[74:75], v[48:49], v[60:61] op_sel:[0,0] op_sel_hi:[0,1]
    v_pk_fma_f32 v[72:73], v[48:49], v[60:61], v[72:73] op_sel:[1,0,0] op_sel_hi:[1,1,1] neg_lo:[1,0,0] neg_hi:[1,0,0]
    v_pk_fma_f32 v[60:61], v[48:49], v[56:57], v[74:75] op_sel:[1,0,0] op_sel_hi:[1,1,1]
    v_mov_b32 v56, v72
    v_mov_b32 v57, v73
    v_pk_mul_f32 v[64:65], v[64:65], v[38:39]
    v_pk_mul_f32 v[66:67], v[66:67], v[38:39] neg_lo:[1,0] neg_hi:[1,0]
    v_cvt_pk_bf16_f32 v85, v64, v65
    v_cvt_pk_bf16_f32 v117, v66, v67
    v_pk_fma_f32 v[68:69], v[10:11], v[102:103], v[58:59] op_sel:[0,0,0] op_sel_hi:[0,1,1]
    v_pk_fma_f32 v[70:71], v[10:11], v[134:135], v[62:63] op_sel:[0,0,0] op_sel_hi:[0,1,1]
    v_pk_fma_f32 v[68:69], v[10:11], v[134:135], v[68:69] op_sel:[1,0,0] op_sel_hi:[1,1,1] neg_lo:[1,0,0] neg_hi:[1,0,0]
    v_pk_fma_f32 v[70:71], v[10:11], v[102:103], v[70:71] op_sel:[1,0,0] op_sel_hi:[1,1,1]
    v_pk_mul_f32 v[76:77], v[50:51], v[58:59] op_sel:[0,0] op_sel_hi:[0,1]
    v_pk_mul_f32 v[78:79], v[50:51], v[62:63] op_sel:[0,0] op_sel_hi:[0,1]
    v_pk_fma_f32 v[76:77], v[50:51], v[62:63], v[76:77] op_sel:[1,0,0] op_sel_hi:[1,1,1] neg_lo:[1,0,0] neg_hi:[1,0,0]
    v_pk_fma_f32 v[62:63], v[50:51], v[58:59], v[78:79] op_sel:[1,0,0] op_sel_hi:[1,1,1]
    v_mov_b32 v58, v76
    v_mov_b32 v59, v77
    v_pk_mul_f32 v[68:69], v[68:69], v[38:39]
    v_pk_mul_f32 v[70:71], v[70:71], v[38:39] neg_lo:[1,0] neg_hi:[1,0]
    v_cvt_pk_bf16_f32 v101, v68, v69
    v_cvt_pk_bf16_f32 v133, v70, v71
    ds_write_b64 v25, v[84:85] offset:2048
    ds_write_b64 v25, v[100:101] offset:2560
    ds_write_b64 v25, v[116:117] offset:3072
    ds_write_b64 v25, v[132:133] offset:3584
    v_pk_fma_f32 v[64:65], v[6:7], v[88:89], v[56:57] op_sel:[0,0,0] op_sel_hi:[0,1,1]
    v_pk_fma_f32 v[66:67], v[6:7], v[120:121], v[60:61] op_sel:[0,0,0] op_sel_hi:[0,1,1]
    v_pk_fma_f32 v[64:65], v[6:7], v[120:121], v[64:65] op_sel:[1,0,0] op_sel_hi:[1,1,1] neg_lo:[1,0,0] neg_hi:[1,0,0]
    v_pk_fma_f32 v[66:67], v[6:7], v[88:89], v[66:67] op_sel:[1,0,0] op_sel_hi:[1,1,1]
    v_pk_mul_f32 v[72:73], v[48:49], v[56:57] op_sel:[0,0] op_sel_hi:[0,1]
    v_pk_mul_f32 v[74:75], v[48:49], v[60:61] op_sel:[0,0] op_sel_hi:[0,1]
    v_pk_fma_f32 v[72:73], v[48:49], v[60:61], v[72:73] op_sel:[1,0,0] op_sel_hi:[1,1,1] neg_lo:[1,0,0] neg_hi:[1,0,0]
    v_pk_fma_f32 v[60:61], v[48:49], v[56:57], v[74:75] op_sel:[1,0,0] op_sel_hi:[1,1,1]
    v_mov_b32 v56, v72
    v_mov_b32 v57, v73
    v_pk_mul_f32 v[64:65], v[64:65], v[40:41]
    v_pk_mul_f32 v[66:67], v[66:67], v[40:41] neg_lo:[1,0] neg_hi:[1,0]
    v_cvt_pk_bf16_f32 v88, v64, v65
    v_cvt_pk_bf16_f32 v120, v66, v67
    v_pk_fma_f32 v[68:69], v[10:11], v[104:105], v[58:59] op_sel:[0,0,0] op_sel_hi:[0,1,1]
    v_pk_fma_f32 v[70:71], v[10:11], v[136:137], v[62:63] op_sel:[0,0,0] op_sel_hi:[0,1,1]
    v_pk_fma_f32 v[68:69], v[10:11], v[136:137], v[68:69] op_sel:[1,0,0] op_sel_hi:[1,1,1] neg_lo:[1,0,0] neg_hi:[1,0,0]
    v_pk_fma_f32 v[70:71], v[10:11], v[104:105], v[70:71] op_sel:[1,0,0] op_sel_hi:[1,1,1]
    v_pk_mul_f32 v[76:77], v[50:51], v[58:59] op_sel:[0,0] op_sel_hi:[0,1]
    v_pk_mul_f32 v[78:79], v[50:51], v[62:63] op_sel:[0,0] op_sel_hi:[0,1]
    v_pk_fma_f32 v[76:77], v[50:51], v[62:63], v[76:77] op_sel:[1,0,0] op_sel_hi:[1,1,1] neg_lo:[1,0,0] neg_hi:[1,0,0]
    v_pk_fma_f32 v[62:63], v[50:51], v[58:59], v[78:79] op_sel:[1,0,0] op_sel_hi:[1,1,1]
    v_mov_b32 v58, v76
    v_mov_b32 v59, v77
    v_pk_mul_f32 v[68:69], v[68:69], v[40:41]
    v_pk_mul_f32 v[70:71], v[70:71], v[40:41] neg_lo:[1,0] neg_hi:[1,0]
    v_cvt_pk_bf16_f32 v104, v68, v69
    v_cvt_pk_bf16_f32 v136, v70, v71
    v_pk_fma_f32 v[64:65], v[6:7], v[90:91], v[56:57] op_sel:[0,0,0] op_sel_hi:[0,1,1]
    v_pk_fma_f32 v[66:67], v[6:7], v[122:123], v[60:61] op_sel:[0,0,0] op_sel_hi:[0,1,1]
    v_pk_fma_f32 v[64:65], v[6:7], v[122:123], v[64:65] op_sel:[1,0,0] op_sel_hi:[1,1,1] neg_lo:[1,0,0] neg_hi:[1,0,0]
    v_pk_fma_f32 v[66:67], v[6:7], v[90:91], v[66:67] op_sel:[1,0,0] op_sel_hi:[1,1,1]
    v_pk_mul_f32 v[72:73], v[48:49], v[56:57] op_sel:[0,0] op_sel_hi:[0,1]
    v_pk_mul_f32 v[74:75], v[48:49], v[60:61] op_sel:[0,0] op_sel_hi:[0,1]
    v_pk_fma_f32 v[72:73], v[48:49], v[60:61], v[72:73] op_sel:[1,0,0] op_sel_hi:[1,1,1] neg_lo:[1,0,0] neg_hi:[1,0,0]
    v_pk_fma_f32 v[60:61], v[48:49], v[56:57], v[74:75] op_sel:[1,0,0] op_sel_hi:[1,1,1]
    v_mov_b32 v56, v72
    v_mov_b32 v57, v73
    v_pk_mul_f32 v[64:65], v[64:65], v[42:43]
    v_pk_mul_f32 v[66:67], v[66:67], v[42:43] neg_lo:[1,0] neg_hi:[1,0]
    v_cvt_pk_bf16_f32 v89, v64, v65
    v_cvt_pk_bf16_f32 v121, v66, v67
    v_pk_fma_f32 v[68:69], v[10:11], v[106:107], v[58:59] op_sel:[0,0,0] op_sel_hi:[0,1,1]
    v_pk_fma_f32 v[70:71], v[10:11], v[138:139], v[62:63] op_sel:[0,0,0] op_sel_hi:[0,1,1]
    v_pk_fma_f32 v[68:69], v[10:11], v[138:139], v[68:69] op_sel:[1,0,0] op_sel_hi:[1,1,1] neg_lo:[1,0,0] neg_hi:[1,0,0]
    v_pk_fma_f32 v[70:71], v[10:11], v[106:107], v[70:71] op_sel:[1,0,0] op_sel_hi:[1,1,1]
    v_pk_mul_f32 v[76:77], v[50:51], v[58:59] op_sel:[0,0] op_sel_hi:[0,1]
    v_pk_mul_f32 v[78:79], v[50:51], v[62:63] op_sel:[0,0] op_sel_hi:[0,1]
    v_pk_fma_f32 v[76:77], v[50:51], v[62:63], v[76:77] op_sel:[1,0,0] op_sel_hi:[1,1,1] neg_lo:[1,0,0] neg_hi:[1,0,0]
    v_pk_fma_f32 v[62:63], v[50:51], v[58:59], v[78:79] op_sel:[1,0,0] op_sel_hi:[1,1,1]
    v_mov_b32 v58, v76
    v_mov_b32 v59, v77
    v_pk_mul_f32 v[68:69], v[68:69], v[42:43]
    v_pk_mul_f32 v[70:71], v[70:71], v[42:43] neg_lo:[1,0] neg_hi:[1,0]
    v_cvt_pk_bf16_f32 v105, v68, v69
    v_cvt_pk_bf16_f32 v137, v70, v71
    ds_write_b64 v25, v[88:89] offset:4096
    ds_write_b64 v25, v[104:105] offset:4608
    ds_write_b64 v25, v[120:121] offset:5120
    ds_write_b64 v25, v[136:137] offset:5632
    v_pk_fma_f32 v[64:65], v[6:7], v[92:93], v[56:57] op_sel:[0,0,0] op_sel_hi:[0,1,1]
    v_pk_fma_f32 v[66:67], v[6:7], v[124:125], v[60:61] op_sel:[0,0,0] op_sel_hi:[0,1,1]
    v_pk_fma_f32 v[64:65], v[6:7], v[124:125], v[64:65] op_sel:[1,0,0] op_sel_hi:[1,1,1] neg_lo:[1,0,0] neg_hi:[1,0,0]
    v_pk_fma_f32 v[66:67], v[6:7], v[92:93], v[66:67] op_sel:[1,0,0] op_sel_hi:[1,1,1]
    v_pk_mul_f32 v[72:73], v[48:49], v[56:57] op_sel:[0,0] op_sel_hi:[0,1]
    v_pk_mul_f32 v[74:75], v[48:49], v[60:61] op_sel:[0,0] op_sel_hi:[0,1]
    v_pk_fma_f32 v[72:73], v[48:49], v[60:61], v[72:73] op_sel:[1,0,0] op_sel_hi:[1,1,1] neg_lo:[1,0,0] neg_hi:[1,0,0]
    v_pk_fma_f32 v[60:61], v[48:49], v[56:57], v[74:75] op_sel:[1,0,0] op_sel_hi:[1,1,1]
    v_mov_b32 v56, v72
    v_mov_b32 v57, v73
    v_pk_mul_f32 v[64:65], v[64:65], v[44:45]
    v_pk_mul_f32 v[66:67], v[66:67], v[44:45] neg_lo:[1,0] neg_hi:[1,0]
    v_cvt_pk_bf16_f32 v92, v64, v65
    v_cvt_pk_bf16_f32 v124, v66, v67
    v_pk_fma_f32 v[68:69], v[10:11], v[108:109], v[58:59] op_sel:[0,0,0] op_sel_hi:[0,1,1]
    v_pk_fma_f32 v[70:71], v[10:11], v[140:141], v[62:63] op_sel:[0,0,0] op_sel_hi:[0,1,1]
    v_pk_fma_f32 v[68:69], v[10:11], v[140:141], v[68:69] op_sel:[1,0,0] op_sel_hi:[1,1,1] neg_lo:[1,0,0] neg_hi:[1,0,0]
    v_pk_fma_f32 v[70:71], v[10:11], v[108:109], v[70:71] op_sel:[1,0,0] op_sel_hi:[1,1,1]
    v_pk_mul_f32 v[76:77], v[50:51], v[58:59] op_sel:[0,0] op_sel_hi:[0,1]
    v_pk_mul_f32 v[78:79], v[50:51], v[62:63] op_sel:[0,0] op_sel_hi:[0,1]
    v_pk_fma_f32 v[76:77], v[50:51], v[62:63], v[76:77] op_sel:[1,0,0] op_sel_hi:[1,1,1] neg_lo:[1,0,0] neg_hi:[1,0,0]
    v_pk_fma_f32 v[62:63], v[50:51], v[58:59], v[78:79] op_sel:[1,0,0] op_sel_hi:[1,1,1]
    v_mov_b32 v58, v76
    v_mov_b32 v59, v77
    v_pk_mul_f32 v[68:69], v[68:69], v[44:45]
    v_pk_mul_f32 v[70:71], v[70:71], v[44:45] neg_lo:[1,0] neg_hi:[1,0]
    v_cvt_pk_bf16_f32 v108, v68, v69
    v_cvt_pk_bf16_f32 v140, v70, v71
    v_pk_fma_f32 v[64:65], v[6:7], v[94:95], v[56:57] op_sel:[0,0,0] op_sel_hi:[0,1,1]
    v_pk_fma_f32 v[66:67], v[6:7], v[126:127], v[60:61] op_sel:[0,0,0] op_sel_hi:[0,1,1]
    v_pk_fma_f32 v[64:65], v[6:7], v[126:127], v[64:65] op_sel:[1,0,0] op_sel_hi:[1,1,1] neg_lo:[1,0,0] neg_hi:[1,0,0]
    v_pk_fma_f32 v[66:67], v[6:7], v[94:95], v[66:67] op_sel:[1,0,0] op_sel_hi:[1,1,1]
    v_pk_mul_f32 v[64:65], v[64:65], v[46:47]
    v_pk_mul_f32 v[66:67], v[66:67], v[46:47] neg_lo:[1,0] neg_hi:[1,0]
    v_cvt_pk_bf16_f32 v93, v64, v65
    v_cvt_pk_bf16_f32 v125, v66, v67
    v_pk_fma_f32 v[68:69], v[10:11], v[110:111], v[58:59] op_sel:[0,0,0] op_sel_hi:[0,1,1]
    v_pk_fma_f32 v[70:71], v[10:11], v[142:143], v[62:63] op_sel:[0,0,0] op_sel_hi:[0,1,1]
    v_pk_fma_f32 v[68:69], v[10:11], v[142:143], v[68:69] op_sel:[1,0,0] op_sel_hi:[1,1,1] neg_lo:[1,0,0] neg_hi:[1,0,0]
    v_pk_fma_f32 v[70:71], v[10:11], v[110:111], v[70:71] op_sel:[1,0,0] op_sel_hi:[1,1,1]
    v_pk_mul_f32 v[68:69], v[68:69], v[46:47]
    v_pk_mul_f32 v[70:71], v[70:71], v[46:47] neg_lo:[1,0] neg_hi:[1,0]
    v_cvt_pk_bf16_f32 v109, v68, v69
    v_cvt_pk_bf16_f32 v141, v70, v71
    ds_write_b64 v25, v[92:93] offset:6144
    ds_write_b64 v25, v[108:109] offset:6656
    ds_write_b64 v25, v[124:125] offset:7168
    ds_write_b64 v25, v[140:141] offset:7680
    s_lshl_b32 s77, s69, 2
    s_add_u32 s77, s77, s68
    s_lshl_b32 s77, s77, 5
    s_add_u32 s77, s77, s70
    s_lshl_b32 s77, s77, 2
    s_add_u32 s71, s77, 33554432
    s_add_u32 s77, s77, 4096
    v_mov_b32 v18, 0
    v_mov_b32 v19, 1
    s_waitcnt vmcnt(0)
    s_mov_b64 exec, 1
    buffer_store_dword v19, v18, s[48:51], s71 offen sc0 sc1
    s_mov_b64 exec, -1
    s_waitcnt lgkmcnt(0)
    ds_read_b64_tr_b16 v[160:161], v28 offset:0
    ds_read_b64_tr_b16 v[162:163], v28 offset:128
    ds_read_b64_tr_b16 v[164:165], v28 offset:1024
    ds_read_b64_tr_b16 v[166:167], v28 offset:1152
    ds_read_b64_tr_b16 v[168:169], v28 offset:2048
    ds_read_b64_tr_b16 v[170:171], v28 offset:2176
    ds_read_b64_tr_b16 v[172:173], v28 offset:3072
    ds_read_b64_tr_b16 v[174:175], v28 offset:3200
    ds_read_b64_tr_b16 v[176:177], v28 offset:4096
    ds_read_b64_tr_b16 v[178:179], v28 offset:4224
    ds_read_b64_tr_b16 v[180:181], v28 offset:5120
    ds_read_b64_tr_b16 v[182:183], v28 offset:5248
    ds_read_b64_tr_b16 v[184:185], v28 offset:6144
    ds_read_b64_tr_b16 v[186:187], v28 offset:6272
    ds_read_b64_tr_b16 v[188:189], v28 offset:7168
    ds_read_b64_tr_b16 v[190:191], v28 offset:7296
    s_waitcnt lgkmcnt(14)
    buffer_store_dwordx4 v[160:163], v24, s[48:51], s90 offen offset:0 sc0 sc1
    s_waitcnt lgkmcnt(12)
    buffer_store_dwordx4 v[164:167], v24, s[48:51], s90 offen offset:2048 sc0 sc1
    s_waitcnt lgkmcnt(10)
    buffer_store_dwordx4 v[168:171], v24, s[48:51], s91 offen offset:0 sc0 sc1
    s_waitcnt lgkmcnt(8)
    buffer_store_dwordx4 v[172:175], v24, s[48:51], s91 offen offset:2048 sc0 sc1
    s_waitcnt lgkmcnt(6)
    buffer_store_dwordx4 v[176:179], v24, s[48:51], s92 offen offset:0 sc0 sc1
    s_waitcnt lgkmcnt(4)
    buffer_store_dwordx4 v[180:183], v24, s[48:51], s92 offen offset:2048 sc0 sc1
    s_waitcnt lgkmcnt(2)
    buffer_store_dwordx4 v[184:187], v24, s[48:51], s93 offen offset:0 sc0 sc1
    s_waitcnt lgkmcnt(0)
    buffer_store_dwordx4 v[188:191], v24, s[48:51], s93 offen offset:2048 sc0 sc1
    s_branch L_k2c_entry
L_k1_kernel_loader:
    s_sub_u32 s68, s68, 4
    v_lshrrev_b32 v16, 3, v1
    v_and_b32 v17, 7, v1
    v_xor_b32 v18, v16, v17
    v_lshlrev_b32 v18, 4, v18
    v_lshrrev_b32 v19, 5, v1
    v_lshlrev_b32 v19, 4, v19
    v_and_b32 v20, 3, v16
    v_add_u32 v19, v19, v20
    s_lshl_b32 s71, s69, 8
    s_lshl_b32 s72, s68, 6
    s_add_u32 s82, s71, s72
    v_add_u32 v19, s82, v19
    v_lshlrev_b32 v19, 11, v19
    v_add_u32 v19, v19, v18
    v_add_u32 v4, 0, v19
    v_add_u32 v5, 64512, v19
    v_add_u32 v6, 6144, v19
    v_add_u32 v7, 70656, v19
    v_add_u32 v8, 16384, v19
    v_add_u32 v9, 80896, v19
    v_add_u32 v10, 22528, v19
    v_add_u32 v11, 87040, v19
    s_lshl_b32 s71, s70, 5
    s_and_b32 s72, s68, 1
    s_lshl_b32 s72, s72, 4
    s_add_u32 s71, s71, s72
    v_add_u32 v19, s71, v16
    v_lshlrev_b32 v19, 11, v19
    v_add_u32 v12, v19, v18
    v_add_u32 v13, 15360, v12
    v_mul_u32_u24 v19, 37, v1
    v_lshrrev_b32 v19, 9, v19
    v_mul_u32_u24 v20, 14, v19
    v_sub_u32 v20, v1, v20
    v_lshlrev_b32 v20, 4, v20
    s_and_b32 s71, s68, 1
    s_lshl_b32 s71, s71, 4
    s_lshr_b32 s72, s68, 1
    s_lshl_b32 s72, s72, 2
    s_add_u32 s71, s71, s72
    v_add_u32 v19, s71, v19
    v_mul_u32_u24 v19, 7168, v19
    v_add_u32 v19, v19, v20
    s_mul_i32 s73, s70, 224
    v_add_u32 v14, s73, v19
    v_add_u32 v15, 56448, v14
    s_lshl_b32 s77, s68, 13
    s_lshl_b32 s78, s68, 11
    s_add_u32 s78, s78, 32768
    s_mul_i32 s79, s68, 1792
    s_add_u32 s79, s79, 122880
    s_lshr_b32 s71, s2, 3
    s_and_b32 s92, s71, 7
    s_waitcnt lgkmcnt(0)
    s_mov_b32 s36, s4
    s_and_b32 s37, s5, 0xffff
    s_mov_b32 s38, 4194304
    s_mov_b32 s39, 0x20000
    s_cmp_lt_u32 s68, 2
    s_cselect_b32 s30, s10, s12
    s_cselect_b32 s31, s11, s13
    s_mov_b32 s40, s30
    s_and_b32 s41, s31, 0xffff
    s_mov_b32 s42, 2097152
    s_mov_b32 s43, 0x20000
    s_mov_b32 s44, s20
    s_and_b32 s45, s21, 0xffff
    s_mov_b32 s46, 7340032
    s_mov_b32 s47, 0x20000
    s_add_u32 s80, s92, 0
    s_and_b32 s80, s80, 15
    s_lshl_b32 s80, s80, 7
    s_add_u32 m0, s77, 0
    s_nop 0
    buffer_load_dwordx4 v4, s[36:39], s80 offen offset:0 lds
    buffer_load_dwordx4 v5, s[36:39], s80 offen offset:1024 lds
    buffer_load_dwordx4 v6, s[36:39], s80 offen offset:2048 lds
    buffer_load_dwordx4 v7, s[36:39], s80 offen offset:3072 lds
    s_add_u32 m0, s77, 4096
    s_nop 0
    buffer_load_dwordx4 v8, s[36:39], s80 offen offset:0 lds
    buffer_load_dwordx4 v9, s[36:39], s80 offen offset:1024 lds
    buffer_load_dwordx4 v10, s[36:39], s80 offen offset:2048 lds
    buffer_load_dwordx4 v11, s[36:39], s80 offen offset:3072 lds
    s_add_u32 m0, s78, 0
    s_nop 0
    buffer_load_dwordx4 v12, s[40:43], s80 offen offset:0 lds
    buffer_load_dwordx4 v13, s[40:43], s80 offen offset:1024 lds
    s_lshl_b32 s80, s92, 1
    s_add_u32 s80, s80, 0
    s_and_b32 s80, s80, 31
    s_mul_i32 s80, s80, 229376
    s_add_u32 m0, s79, 0
    s_mov_b32 exec_hi, 0x00ffffff
    buffer_load_dwordx4 v14, s[44:47], s80 offen offset:0 lds
    buffer_load_dwordx4 v15, s[44:47], s80 offen offset:896 lds
    s_mov_b32 exec_hi, -1
    s_lshl_b32 s80, s92, 1
    s_add_u32 s80, s80, 1
    s_and_b32 s80, s80, 31
    s_mul_i32 s80, s80, 229376
    s_add_u32 m0, s79, 7168
    s_mov_b32 exec_hi, 0x00ffffff
    buffer_load_dwordx4 v14, s[44:47], s80 offen offset:0 lds
    buffer_load_dwordx4 v15, s[44:47], s80 offen offset:896 lds
    s_mov_b32 exec_hi, -1
    s_add_u32 s80, s92, 1
    s_and_b32 s80, s80, 15
    s_lshl_b32 s80, s80, 7
    s_add_u32 m0, s77, 40960
    s_nop 0
    buffer_load_dwordx4 v4, s[36:39], s80 offen offset:0 lds
    buffer_load_dwordx4 v5, s[36:39], s80 offen offset:1024 lds
    buffer_load_dwordx4 v6, s[36:39], s80 offen offset:2048 lds
    buffer_load_dwordx4 v7, s[36:39], s80 offen offset:3072 lds
    s_add_u32 m0, s77, 45056
    s_nop 0
    buffer_load_dwordx4 v8, s[36:39], s80 offen offset:0 lds
    buffer_load_dwordx4 v9, s[36:39], s80 offen offset:1024 lds
    buffer_load_dwordx4 v10, s[36:39], s80 offen offset:2048 lds
    buffer_load_dwordx4 v11, s[36:39], s80 offen offset:3072 lds
    s_add_u32 m0, s78, 40960
    s_nop 0
    buffer_load_dwordx4 v12, s[40:43], s80 offen offset:0 lds
    buffer_load_dwordx4 v13, s[40:43], s80 offen offset:1024 lds
    s_lshl_b32 s80, s92, 1
    s_add_u32 s80, s80, 2
    s_and_b32 s80, s80, 31
    s_mul_i32 s80, s80, 229376
    s_add_u32 m0, s79, 14336
    s_mov_b32 exec_hi, 0x00ffffff
    buffer_load_dwordx4 v14, s[44:47], s80 offen offset:0 lds
    buffer_load_dwordx4 v15, s[44:47], s80 offen offset:896 lds
    s_mov_b32 exec_hi, -1
    s_mov_b32 s48, s34
    s_and_b32 s49, s35, 0xffff
    s_mov_b32 s50, 50331648
    s_mov_b32 s51, 0x20000
    s_mov_b32 s52, s32
    s_and_b32 s53, s33, 0xffff
    s_mov_b32 s54, 256
    s_mov_b32 s55, 0x20000
    s_waitcnt vmcnt(12)
    s_barrier
    s_lshl_b32 s80, s92, 1
    s_add_u32 s80, s80, 3
    s_and_b32 s80, s80, 31
    s_mul_i32 s80, s80, 229376
    s_add_u32 m0, s79, 21504
    s_mov_b32 exec_hi, 0x00ffffff
    buffer_load_dwordx4 v14, s[44:47], s80 offen offset:0 lds
    buffer_load_dwordx4 v15, s[44:47], s80 offen offset:896 lds
    s_mov_b32 exec_hi, -1
    s_add_u32 s80, s92, 2
    s_and_b32 s80, s80, 15
    s_lshl_b32 s80, s80, 7
    s_add_u32 m0, s77, 81920
    s_nop 0
    buffer_load_dwordx4 v4, s[36:39], s80 offen offset:0 lds
    buffer_load_dwordx4 v5, s[36:39], s80 offen offset:1024 lds
    buffer_load_dwordx4 v6, s[36:39], s80 offen offset:2048 lds
    buffer_load_dwordx4 v7, s[36:39], s80 offen offset:3072 lds
    s_add_u32 m0, s77, 86016
    s_nop 0
    buffer_load_dwordx4 v8, s[36:39], s80 offen offset:0 lds
    buffer_load_dwordx4 v9, s[36:39], s80 offen offset:1024 lds
    buffer_load_dwordx4 v10, s[36:39], s80 offen offset:2048 lds
    buffer_load_dwordx4 v11, s[36:39], s80 offen offset:3072 lds
    s_add_u32 m0, s78, 81920
    s_nop 0
    buffer_load_dwordx4 v12, s[40:43], s80 offen offset:0 lds
    buffer_load_dwordx4 v13, s[40:43], s80 offen offset:1024 lds
    s_lshl_b32 s80, s92, 1
    s_add_u32 s80, s80, 4
    s_and_b32 s80, s80, 31
    s_mul_i32 s80, s80, 229376
    s_add_u32 m0, s79, 28672
    s_mov_b32 exec_hi, 0x00ffffff
    buffer_load_dwordx4 v14, s[44:47], s80 offen offset:0 lds
    buffer_load_dwordx4 v15, s[44:47], s80 offen offset:896 lds
    s_mov_b32 exec_hi, -1
    s_lshl_b32 s81, s69, 5
    s_add_u32 s81, s81, s70
    s_lshl_b32 s81, s81, 15
    s_lshl_b32 s71, s68, 13
    s_add_u32 s81, s81, s71
    s_add_u32 s81, s81, 37748736
    v_lshlrev_b32 v21, 4, v1
    v_mov_b32 v200, -1
    v_mov_b32 v201, -1
    v_mov_b32 v202, -1
    v_mov_b32 v203, -1
    v_lshlrev_b32 v22, 2, v1
    v_lshlrev_b32 v206, 4, v1
    s_lshl_b32 s83, s69, 5
    s_add_u32 s83, s83, s70
    s_lshl_b32 s71, s2, 2
    s_add_u32 s71, s71, s68
    s_mul_i32 s72, s71, 7168
    s_add_u32 s94, s24, s72
    s_addc_u32 s95, s25, 0
    s_cmp_lt_u32 s71, 512
    s_cselect_b32 s96, s14, s16
    s_cselect_b32 s97, s15, s17
    s_cselect_b32 s98, s10, s12
    s_cselect_b32 s99, s11, s13
    s_and_b32 s71, s71, 511
    s_lshl_b32 s71, s71, 12
    s_add_u32 s96, s96, s71
    s_addc_u32 s97, s97, 0
    s_add_u32 s98, s98, s71
    s_addc_u32 s99, s99, 0
    s_mov_b32 s56, s28
    s_and_b32 s57, s29, 0xffff
    s_mov_b32 s58, 2048
    s_mov_b32 s59, 0x20000
    s_lshl_b32 s71, s69, 8
    s_lshl_b32 s72, s70, 3
    s_add_u32 s71, s71, s72
    s_lshl_b32 s72, s68, 1
    s_add_u32 s74, s71, s72
    s_lshl_b32 s71, s74, 11
    v_lshlrev_b32 v19, 5, v1
    buffer_load_dwordx4 v[32:35], v19, s[36:39], s71 offen offset:0
    buffer_load_dwordx4 v[36:39], v19, s[36:39], s71 offen offset:16
    buffer_load_dwordx4 v[40:43], v19, s[36:39], s71 offen offset:2048
    buffer_load_dwordx4 v[44:47], v19, s[36:39], s71 offen offset:2064
    buffer_load_dwordx4 v[48:51], v19, s[56:59], 0 offen offset:0
    buffer_load_dwordx4 v[52:55], v19, s[56:59], 0 offen offset:16
    s_lshl_b32 s71, s70, 6
    v_and_b32 v19, 31, v1
    v_lshlrev_b32 v19, 1, v19
    v_add_u32 v19, s71, v19
    s_mov_b32 s56, s6
    s_and_b32 s57, s7, 0xffff
    s_mov_b32 s58, 2048
    s_mov_b32 s59, 0x20000
    s_mov_b32 s60, s8
    s_and_b32 s61, s9, 0xffff
    s_mov_b32 s62, 2048
    s_mov_b32 s63, 0x20000
    s_mov_b32 s64, s18
    s_and_b32 s65, s19, 0xffff
    s_mov_b32 s66, 2048
    s_mov_b32 s67, 0x20000
    buffer_load_ushort v88, v19, s[56:59], 0 offen offset:0
    buffer_load_ushort v89, v19, s[60:63], 0 offen offset:0
    buffer_load_ushort v90, v19, s[64:67], 0 offen offset:0
    v_mul_u32_u24 v30, 7168, v16
    v_lshlrev_b32 v20, 3, v17
    v_add_u32 v30, v30, v20
    s_mul_i32 s93, s69, 917504
    s_add_u32 s93, s93, s73
    s_mul_i32 s72, s68, 56
    s_add_u32 s93, s93, s72
    s_lshl_b32 s71, s2, 1
    s_and_b32 s72, s68, 1
    s_add_u32 s71, s71, s72
    s_lshl_b32 s71, s71, 12
    v_lshlrev_b32 v197, 6, v1
    buffer_load_dword v198, v197, s[40:43], s71 offen
    s_waitcnt vmcnt(24)
    s_barrier
    s_lshl_b32 s80, s92, 1
    s_add_u32 s80, s80, 5
    s_and_b32 s80, s80, 31
    s_mul_i32 s80, s80, 229376
    s_add_u32 m0, s79, 0
    s_mov_b32 exec_hi, 0x00ffffff
    buffer_load_dwordx4 v14, s[44:47], s80 offen offset:0 lds
    buffer_load_dwordx4 v15, s[44:47], s80 offen offset:896 lds
    s_mov_b32 exec_hi, -1
    buffer_load_dwordx2 v[56:57], v30, s[44:47], s93 offen
    s_add_u32 s93, s93, 57344
    buffer_load_dwordx2 v[58:59], v30, s[44:47], s93 offen
    s_add_u32 s93, s93, 57344
    buffer_load_dwordx2 v[60:61], v30, s[44:47], s93 offen
    s_add_u32 s93, s93, 57344
    buffer_load_dwordx2 v[62:63], v30, s[44:47], s93 offen
    s_add_u32 s93, s93, 57344
    s_waitcnt vmcnt(28)
    s_barrier
    s_add_u32 s80, s92, 3
    s_and_b32 s80, s80, 15
    s_lshl_b32 s80, s80, 7
    s_add_u32 m0, s77, 0
    s_nop 0
    buffer_load_dwordx4 v4, s[36:39], s80 offen offset:0 lds
    buffer_load_dwordx4 v5, s[36:39], s80 offen offset:1024 lds
    buffer_load_dwordx4 v6, s[36:39], s80 offen offset:2048 lds
    buffer_load_dwordx4 v7, s[36:39], s80 offen offset:3072 lds
    s_add_u32 m0, s78, 0
    s_nop 0
    buffer_load_dwordx4 v12, s[40:43], s80 offen offset:0 lds
    s_lshl_b32 s80, s92, 1
    s_add_u32 s80, s80, 6
    s_and_b32 s80, s80, 31
    s_mul_i32 s80, s80, 229376
    s_add_u32 m0, s79, 7168
    s_mov_b32 exec_hi, 0x00ffffff
    buffer_load_dwordx4 v14, s[44:47], s80 offen offset:0 lds
    buffer_load_dwordx4 v15, s[44:47], s80 offen offset:896 lds
    s_mov_b32 exec_hi, -1
    buffer_load_dwordx2 v[64:65], v30, s[44:47], s93 offen
    s_add_u32 s93, s93, 57344
    buffer_load_dwordx2 v[66:67], v30, s[44:47], s93 offen
    s_add_u32 s93, s93, 57344
    buffer_load_dwordx2 v[68:69], v30, s[44:47], s93 offen
    s_add_u32 s93, s93, 57344
    buffer_load_dwordx2 v[70:71], v30, s[44:47], s93 offen
    s_add_u32 s93, s93, 57344
    s_waitcnt vmcnt(17)
    s_barrier
    s_add_u32 s80, s92, 3
    s_and_b32 s80, s80, 15
    s_lshl_b32 s80, s80, 7
    s_add_u32 m0, s77, 4096
    s_nop 0
    buffer_load_dwordx4 v8, s[36:39], s80 offen offset:0 lds
    buffer_load_dwordx4 v9, s[36:39], s80 offen offset:1024 lds
    buffer_load_dwordx4 v10, s[36:39], s80 offen offset:2048 lds
    buffer_load_dwordx4 v11, s[36:39], s80 offen offset:3072 lds
    s_add_u32 m0, s78, 0
    s_nop 0
    buffer_load_dwordx4 v13, s[40:43], s80 offen offset:1024 lds
    s_lshl_b32 s80, s92, 1
    s_add_u32 s80, s80, 7
    s_and_b32 s80, s80, 31
    s_mul_i32 s80, s80, 229376
    s_add_u32 m0, s79, 14336
    s_mov_b32 exec_hi, 0x00ffffff
    buffer_load_dwordx4 v14, s[44:47], s80 offen offset:0 lds
    buffer_load_dwordx4 v15, s[44:47], s80 offen offset:896 lds
    s_mov_b32 exec_hi, -1
    buffer_load_dwordx2 v[72:73], v30, s[44:47], s93 offen
    s_add_u32 s93, s93, 57344
    buffer_load_dwordx2 v[74:75], v30, s[44:47], s93 offen
    s_add_u32 s93, s93, 57344
    buffer_load_dwordx2 v[76:77], v30, s[44:47], s93 offen
    s_add_u32 s93, s93, 57344
    buffer_load_dwordx2 v[78:79], v30, s[44:47], s93 offen
    s_add_u32 s93, s93, 57344
    s_nop 1
    v_lshlrev_b32 v128, 16, v48
    v_and_b32 v129, 0xffff0000, v48
    v_lshlrev_b32 v96, 16, v32
    v_and_b32 v97, 0xffff0000, v32
    v_lshlrev_b32 v112, 16, v40
    v_and_b32 v113, 0xffff0000, v40
    v_lshlrev_b32 v130, 16, v49
    v_and_b32 v131, 0xffff0000, v49
    v_lshlrev_b32 v98, 16, v33
    v_and_b32 v99, 0xffff0000, v33
    v_lshlrev_b32 v114, 16, v41
    v_and_b32 v115, 0xffff0000, v41
    v_lshlrev_b32 v132, 16, v50
    v_and_b32 v133, 0xffff0000, v50
    v_lshlrev_b32 v100, 16, v34
    v_and_b32 v101, 0xffff0000, v34
    v_lshlrev_b32 v116, 16, v42
    v_and_b32 v117, 0xffff0000, v42
    v_lshlrev_b32 v134, 16, v51
    v_and_b32 v135, 0xffff0000, v51
    v_lshlrev_b32 v102, 16, v35
    v_and_b32 v103, 0xffff0000, v35
    v_lshlrev_b32 v118, 16, v43
    v_and_b32 v119, 0xffff0000, v43
    v_lshlrev_b32 v136, 16, v52
    v_and_b32 v137, 0xffff0000, v52
    v_lshlrev_b32 v104, 16, v36
    v_and_b32 v105, 0xffff0000, v36
    v_lshlrev_b32 v120, 16, v44
    v_and_b32 v121, 0xffff0000, v44
    v_lshlrev_b32 v138, 16, v53
    v_and_b32 v139, 0xffff0000, v53
    v_lshlrev_b32 v106, 16, v37
    v_and_b32 v107, 0xffff0000, v37
    v_lshlrev_b32 v122, 16, v45
    v_and_b32 v123, 0xffff0000, v45
    v_lshlrev_b32 v140, 16, v54
    v_and_b32 v141, 0xffff0000, v54
    v_lshlrev_b32 v108, 16, v38
    v_and_b32 v109, 0xffff0000, v38
    v_lshlrev_b32 v124, 16, v46
    v_and_b32 v125, 0xffff0000, v46
    v_lshlrev_b32 v142, 16, v55
    v_and_b32 v143, 0xffff0000, v55
    v_lshlrev_b32 v110, 16, v39
    v_and_b32 v111, 0xffff0000, v39
    v_lshlrev_b32 v126, 16, v47
    v_and_b32 v127, 0xffff0000, v47
    v_mov_b32 v176, 0x3f803f80
    v_pk_add_f32 v[172:173], v[96:97], v[98:99]
    v_pk_add_f32 v[172:173], v[172:173], v[100:101]
    v_pk_add_f32 v[172:173], v[172:173], v[102:103]
    v_pk_add_f32 v[172:173], v[172:173], v[104:105]
    v_pk_add_f32 v[172:173], v[172:173], v[106:107]
    v_pk_add_f32 v[172:173], v[172:173], v[108:109]
    v_pk_add_f32 v[172:173], v[172:173], v[110:111]
    v_add_f32 v144, v172, v173
    v_pk_add_f32 v[174:175], v[112:113], v[114:115]
    v_pk_add_f32 v[174:175], v[174:175], v[116:117]
    v_pk_add_f32 v[174:175], v[174:175], v[118:119]
    v_pk_add_f32 v[174:175], v[174:175], v[120:121]
    v_pk_add_f32 v[174:175], v[174:175], v[122:123]
    v_pk_add_f32 v[174:175], v[174:175], v[124:125]
    v_pk_add_f32 v[174:175], v[174:175], v[126:127]
    v_add_f32 v145, v174, v175
    s_nop 1
    v_add_f32_dpp v144, v144, v144 quad_perm:[1,0,3,2] row_mask:0xf bank_mask:0xf
    v_add_f32_dpp v145, v145, v145 quad_perm:[1,0,3,2] row_mask:0xf bank_mask:0xf
    s_nop 1
    v_add_f32_dpp v144, v144, v144 quad_perm:[2,3,0,1] row_mask:0xf bank_mask:0xf
    v_add_f32_dpp v145, v145, v145 quad_perm:[2,3,0,1] row_mask:0xf bank_mask:0xf
    s_nop 1
    v_add_f32_dpp v144, v144, v144 row_half_mirror row_mask:0xf bank_mask:0xf
    v_add_f32_dpp v145, v145, v145 row_half_mirror row_mask:0xf bank_mask:0xf
    s_nop 1
    v_add_f32_dpp v144, v144, v144 row_mirror row_mask:0xf bank_mask:0xf
    v_add_f32_dpp v145, v145, v145 row_mirror row_mask:0xf bank_mask:0xf
    s_nop 1
    v_readlane_b32 s84, v144, 0
    v_readlane_b32 s85, v144, 16
    v_readlane_b32 s86, v144, 32
    v_readlane_b32 s87, v144, 48
    v_readlane_b32 s88, v145, 0
    v_readlane_b32 s89, v145, 16
    v_readlane_b32 s90, v145, 32
    v_readlane_b32 s91, v145, 48
    s_nop 2
    v_mov_b32 v144, s84
    v_add_f32 v144, s85, v144
    v_add_f32 v144, s86, v144
    v_add_f32 v144, s87, v144
    v_mov_b32 v145, s88
    v_add_f32 v145, s89, v145
    v_add_f32 v145, s90, v145
    v_add_f32 v145, s91, v145
    v_mul_f32 v144, 0x3a800000, v144
    v_mul_f32 v145, 0x3a800000, v145
    v_mov_b32 v148, 0
    v_pk_mul_f32 v[152:153], v[96:97], v[128:129]
    v_cvt_pk_bf16_f32 v152, v152, v153
    v_dot2_f32_bf16 v148, v152, v176, v148
    v_pk_mul_f32 v[154:155], v[98:99], v[130:131]
    v_cvt_pk_bf16_f32 v154, v154, v155
    v_dot2_f32_bf16 v148, v154, v176, v148
    v_pk_mul_f32 v[152:153], v[100:101], v[132:133]
    v_cvt_pk_bf16_f32 v152, v152, v153
    v_dot2_f32_bf16 v148, v152, v176, v148
    v_pk_mul_f32 v[154:155], v[102:103], v[134:135]
    v_cvt_pk_bf16_f32 v154, v154, v155
    v_dot2_f32_bf16 v148, v154, v176, v148
    v_pk_mul_f32 v[152:153], v[104:105], v[136:137]
    v_cvt_pk_bf16_f32 v152, v152, v153
    v_dot2_f32_bf16 v148, v152, v176, v148
    v_pk_mul_f32 v[154:155], v[106:107], v[138:139]
    v_cvt_pk_bf16_f32 v154, v154, v155
    v_dot2_f32_bf16 v148, v154, v176, v148
    v_pk_mul_f32 v[152:153], v[108:109], v[140:141]
    v_cvt_pk_bf16_f32 v152, v152, v153
    v_dot2_f32_bf16 v148, v152, v176, v148
    v_pk_mul_f32 v[154:155], v[110:111], v[142:143]
    s_waitcnt vmcnt(22)
    s_barrier
    s_add_u32 s80, s92, 4
    s_and_b32 s80, s80, 15
    s_lshl_b32 s80, s80, 7
    s_add_u32 m0, s77, 40960
    s_nop 0
    buffer_load_dwordx4 v4, s[36:39], s80 offen offset:0 lds
    buffer_load_dwordx4 v5, s[36:39], s80 offen offset:1024 lds
    buffer_load_dwordx4 v6, s[36:39], s80 offen offset:2048 lds
    buffer_load_dwordx4 v7, s[36:39], s80 offen offset:3072 lds
    s_add_u32 m0, s78, 40960
    s_nop 0
    buffer_load_dwordx4 v12, s[40:43], s80 offen offset:0 lds
    s_lshl_b32 s80, s92, 1
    s_add_u32 s80, s80, 8
    s_and_b32 s80, s80, 31
    s_mul_i32 s80, s80, 229376
    s_add_u32 m0, s79, 21504
    s_mov_b32 exec_hi, 0x00ffffff
    buffer_load_dwordx4 v14, s[44:47], s80 offen offset:0 lds
    buffer_load_dwordx4 v15, s[44:47], s80 offen offset:896 lds
    s_mov_b32 exec_hi, -1
    buffer_load_dwordx2 v[80:81], v30, s[44:47], s93 offen
    s_add_u32 s93, s93, 57344
    buffer_load_dwordx2 v[82:83], v30, s[44:47], s93 offen
    s_add_u32 s93, s93, 57344
    buffer_load_dwordx2 v[84:85], v30, s[44:47], s93 offen
    s_add_u32 s93, s93, 57344
    buffer_load_dwordx2 v[86:87], v30, s[44:47], s93 offen
    s_add_u32 s93, s93, 57344
    s_nop 1
    v_cvt_pk_bf16_f32 v154, v154, v155
    v_dot2_f32_bf16 v148, v154, v176, v148
    v_mov_b32 v149, 0
    v_pk_mul_f32 v[152:153], v[112:113], v[128:129]
    v_cvt_pk_bf16_f32 v152, v152, v153
    v_dot2_f32_bf16 v149, v152, v176, v149
    v_pk_mul_f32 v[154:155], v[114:115], v[130:131]
    v_cvt_pk_bf16_f32 v154, v154, v155
    v_dot2_f32_bf16 v149, v154, v176, v149
    v_pk_mul_f32 v[152:153], v[116:117], v[132:133]
    v_cvt_pk_bf16_f32 v152, v152, v153
    v_dot2_f32_bf16 v149, v152, v176, v149
    v_pk_mul_f32 v[154:155], v[118:119], v[134:135]
    v_cvt_pk_bf16_f32 v154, v154, v155
    v_dot2_f32_bf16 v149, v154, v176, v149
    v_pk_mul_f32 v[152:153], v[120:121], v[136:137]
    v_cvt_pk_bf16_f32 v152, v152, v153
    v_dot2_f32_bf16 v149, v152, v176, v149
    v_pk_mul_f32 v[154:155], v[122:123], v[138:139]
    v_cvt_pk_bf16_f32 v154, v154, v155
    v_dot2_f32_bf16 v149, v154, v176, v149
    v_pk_mul_f32 v[152:153], v[124:125], v[140:141]
    v_cvt_pk_bf16_f32 v152, v152, v153
    v_dot2_f32_bf16 v149, v152, v176, v149
    v_pk_mul_f32 v[154:155], v[126:127], v[142:143]
    v_cvt_pk_bf16_f32 v154, v154, v155
    v_dot2_f32_bf16 v149, v154, v176, v149
    v_mov_b32 v172, 0
    v_mov_b32 v173, 0
    v_pk_add_f32 v[152:153], v[96:97], v[144:145] op_sel:[0,0] op_sel_hi:[1,0] neg_lo:[0,1] neg_hi:[0,1]
    v_pk_fma_f32 v[172:173], v[152:153], v[152:153], v[172:173]
    v_pk_add_f32 v[154:155], v[98:99], v[144:145] op_sel:[0,0] op_sel_hi:[1,0] neg_lo:[0,1] neg_hi:[0,1]
    v_pk_fma_f32 v[172:173], v[154:155], v[154:155], v[172:173]
    v_pk_add_f32 v[152:153], v[100:101], v[144:145] op_sel:[0,0] op_sel_hi:[1,0] neg_lo:[0,1] neg_hi:[0,1]
    v_pk_fma_f32 v[172:173], v[152:153], v[152:153], v[172:173]
    v_pk_add_f32 v[154:155], v[102:103], v[144:145] op_sel:[0,0] op_sel_hi:[1,0] neg_lo:[0,1] neg_hi:[0,1]
    v_pk_fma_f32 v[172:173], v[154:155], v[154:155], v[172:173]
    v_pk_add_f32 v[152:153], v[104:105], v[144:145] op_sel:[0,0] op_sel_hi:[1,0] neg_lo:[0,1] neg_hi:[0,1]
    v_pk_fma_f32 v[172:173], v[152:153], v[152:153], v[172:173]
    v_pk_add_f32 v[154:155], v[106:107], v[144:145] op_sel:[0,0] op_sel_hi:[1,0] neg_lo:[0,1] neg_hi:[0,1]
    v_pk_fma_f32 v[172:173], v[154:155], v[154:155], v[172:173]
    v_pk_add_f32 v[152:153], v[108:109], v[144:145] op_sel:[0,0] op_sel_hi:[1,0] neg_lo:[0,1] neg_hi:[0,1]
    v_pk_fma_f32 v[172:173], v[152:153], v[152:153], v[172:173]
    v_pk_add_f32 v[154:155], v[110:111], v[144:145] op_sel:[0,0] op_sel_hi:[1,0] neg_lo:[0,1] neg_hi:[0,1]
    v_pk_fma_f32 v[172:173], v[154:155], v[154:155], v[172:173]
    v_add_f32 v146, v172, v173
    v_mov_b32 v174, 0
    v_mov_b32 v175, 0
    v_pk_add_f32 v[152:153], v[112:113], v[144:145] op_sel:[0,1] op_sel_hi:[1,1] neg_lo:[0,1] neg_hi:[0,1]
    v_pk_fma_f32 v[174:175], v[152:153], v[152:153], v[174:175]
    v_pk_add_f32 v[154:155], v[114:115], v[144:145] op_sel:[0,1] op_sel_hi:[1,1] neg_lo:[0,1] neg_hi:[0,1]
    v_pk_fma_f32 v[174:175], v[154:155], v[154:155], v[174:175]
    v_pk_add_f32 v[152:153], v[116:117], v[144:145] op_sel:[0,1] op_sel_hi:[1,1] neg_lo:[0,1] neg_hi:[0,1]
    v_pk_fma_f32 v[174:175], v[152:153], v[152:153], v[174:175]
    v_pk_add_f32 v[154:155], v[118:119], v[144:145] op_sel:[0,1] op_sel_hi:[1,1] neg_lo:[0,1] neg_hi:[0,1]
    v_pk_fma_f32 v[174:175], v[154:155], v[154:155], v[174:175]
    v_pk_add_f32 v[152:153], v[120:121], v[144:145] op_sel:[0,1] op_sel_hi:[1,1] neg_lo:[0,1] neg_hi:[0,1]
    v_pk_fma_f32 v[174:175], v[152:153], v[152:153], v[174:175]
    v_pk_add_f32 v[154:155], v[122:123], v[144:145] op_sel:[0,1] op_sel_hi:[1,1] neg_lo:[0,1] neg_hi:[0,1]
    v_pk_fma_f32 v[174:175], v[154:155], v[154:155], v[174:175]
    v_pk_add_f32 v[152:153], v[124:125], v[144:145] op_sel:[0,1] op_sel_hi:[1,1] neg_lo:[0,1] neg_hi:[0,1]
    v_pk_fma_f32 v[174:175], v[152:153], v[152:153], v[174:175]
    v_pk_add_f32 v[154:155], v[126:127], v[144:145] op_sel:[0,1] op_sel_hi:[1,1] neg_lo:[0,1] neg_hi:[0,1]
    v_pk_fma_f32 v[174:175], v[154:155], v[154:155], v[174:175]
    v_add_f32 v147, v174, v175
    s_nop 1
    v_add_f32_dpp v146, v146, v146 quad_perm:[1,0,3,2] row_mask:0xf bank_mask:0xf
    v_add_f32_dpp v147, v147, v147 quad_perm:[1,0,3,2] row_mask:0xf bank_mask:0xf
    s_nop 1
    v_add_f32_dpp v146, v146, v146 quad_perm:[2,3,0,1] row_mask:0xf bank_mask:0xf
    v_add_f32_dpp v147, v147, v147 quad_perm:[2,3,0,1] row_mask:0xf bank_mask:0xf
    s_nop 1
    v_add_f32_dpp v146, v146, v146 row_half_mirror row_mask:0xf bank_mask:0xf
    v_add_f32_dpp v147, v147, v147 row_half_mirror row_mask:0xf bank_mask:0xf
    s_nop 1
    v_add_f32_dpp v146, v146, v146 row_mirror row_mask:0xf bank_mask:0xf
    v_add_f32_dpp v147, v147, v147 row_mirror row_mask:0xf bank_mask:0xf
    s_nop 1
    v_readlane_b32 s84, v146, 0
    v_readlane_b32 s85, v146, 16
    v_readlane_b32 s86, v146, 32
    v_readlane_b32 s87, v146, 48
    v_readlane_b32 s88, v147, 0
    v_readlane_b32 s89, v147, 16
    v_readlane_b32 s90, v147, 32
    v_readlane_b32 s91, v147, 48
    s_nop 2
    v_mov_b32 v146, s84
    v_add_f32 v146, s85, v146
    v_add_f32 v146, s86, v146
    v_add_f32 v146, s87, v146
    v_mov_b32 v147, s88
    v_add_f32 v147, s89, v147
    v_add_f32 v147, s90, v147
    v_add_f32 v147, s91, v147
    s_nop 1
    v_add_f32_dpp v148, v148, v148 quad_perm:[1,0,3,2] row_mask:0xf bank_mask:0xf
    v_add_f32_dpp v149, v149, v149 quad_perm:[1,0,3,2] row_mask:0xf bank_mask:0xf
    s_nop 1
    v_add_f32_dpp v148, v148, v148 quad_perm:[2,3,0,1] row_mask:0xf bank_mask:0xf
    s_waitcnt vmcnt(17)
    s_barrier
    s_add_u32 s80, s92, 4
    s_and_b32 s80, s80, 15
    s_lshl_b32 s80, s80, 7
    s_add_u32 m0, s77, 45056
    s_nop 0
    buffer_load_dwordx4 v8, s[36:39], s80 offen offset:0 lds
    buffer_load_dwordx4 v9, s[36:39], s80 offen offset:1024 lds
    buffer_load_dwordx4 v10, s[36:39], s80 offen offset:2048 lds
    buffer_load_dwordx4 v11, s[36:39], s80 offen offset:3072 lds
    s_add_u32 m0, s78, 40960
    s_nop 0
    buffer_load_dwordx4 v13, s[40:43], s80 offen offset:1024 lds
    s_lshl_b32 s80, s92, 1
    s_add_u32 s80, s80, 9
    s_and_b32 s80, s80, 31
    s_mul_i32 s80, s80, 229376
    s_add_u32 m0, s79, 28672
    s_mov_b32 exec_hi, 0x00ffffff
    buffer_load_dwordx4 v14, s[44:47], s80 offen offset:0 lds
    buffer_load_dwordx4 v15, s[44:47], s80 offen offset:896 lds
    s_mov_b32 exec_hi, -1
    s_nop 1
    v_add_f32_dpp v149, v149, v149 quad_perm:[2,3,0,1] row_mask:0xf bank_mask:0xf
    s_nop 1
    v_add_f32_dpp v148, v148, v148 row_half_mirror row_mask:0xf bank_mask:0xf
    v_add_f32_dpp v149, v149, v149 row_half_mirror row_mask:0xf bank_mask:0xf
    s_nop 1
    v_add_f32_dpp v148, v148, v148 row_mirror row_mask:0xf bank_mask:0xf
    v_add_f32_dpp v149, v149, v149 row_mirror row_mask:0xf bank_mask:0xf
    s_nop 1
    v_readlane_b32 s84, v148, 0
    v_readlane_b32 s85, v148, 16
    v_readlane_b32 s86, v148, 32
    v_readlane_b32 s87, v148, 48
    v_readlane_b32 s88, v149, 0
    v_readlane_b32 s89, v149, 16
    v_readlane_b32 s90, v149, 32
    v_readlane_b32 s91, v149, 48
    s_nop 2
    v_mov_b32 v148, s84
    v_add_f32 v148, s85, v148
    v_add_f32 v148, s86, v148
    v_add_f32 v148, s87, v148
    v_mov_b32 v149, s88
    v_add_f32 v149, s89, v149
    v_add_f32 v149, s90, v149
    v_add_f32 v149, s91, v149
    v_cvt_pk_bf16_f32 v144, v144, v144
    v_lshlrev_b32 v144, 16, v144
    v_mul_f32 v146, 0x3a800000, v146
    v_cvt_pk_bf16_f32 v146, v146, v146
    v_lshlrev_b32 v146, 16, v146
    v_add_f32 v146, 0x3727c5ac, v146
    v_cvt_pk_bf16_f32 v146, v146, v146
    v_lshlrev_b32 v146, 16, v146
    v_sqrt_f32 v146, v146
    s_nop 1
    v_cvt_pk_bf16_f32 v146, v146, v146
    v_lshlrev_b32 v146, 16, v146
    v_rcp_f32 v160, v146
    s_nop 1
    v_mul_f32 v161, v160, v144
    v_cvt_pk_bf16_f32 v148, v148, v148
    v_lshlrev_b32 v148, 16, v148
    v_mul_f32 v148, 0xbfb8aa3b, v148
    v_exp_f32 v148, v148
    s_nop 1
    v_add_f32 v148, 1.0, v148
    v_rcp_f32 v163, v148
    s_nop 1
    v_cvt_pk_bf16_f32 v163, v163, v163
    v_lshlrev_b32 v163, 16, v163
    v_sub_f32 v162, 1.0, v163
    v_cvt_pk_bf16_f32 v162, v162, v162
    v_lshlrev_b32 v162, 16, v162
    v_cvt_pk_bf16_f32 v145, v145, v145
    v_lshlrev_b32 v145, 16, v145
    v_mul_f32 v147, 0x3a800000, v147
    v_cvt_pk_bf16_f32 v147, v147, v147
    v_lshlrev_b32 v147, 16, v147
    v_add_f32 v147, 0x3727c5ac, v147
    v_cvt_pk_bf16_f32 v147, v147, v147
    s_waitcnt vmcnt(18)
    s_barrier
    s_add_u32 s80, s92, 5
    s_and_b32 s80, s80, 15
    s_lshl_b32 s80, s80, 7
    s_add_u32 m0, s77, 81920
    s_nop 0
    buffer_load_dwordx4 v4, s[36:39], s80 offen offset:0 lds
    buffer_load_dwordx4 v5, s[36:39], s80 offen offset:1024 lds
    buffer_load_dwordx4 v6, s[36:39], s80 offen offset:2048 lds
    buffer_load_dwordx4 v7, s[36:39], s80 offen offset:3072 lds
    s_add_u32 m0, s78, 81920
    s_nop 0
    buffer_load_dwordx4 v12, s[40:43], s80 offen offset:0 lds
    s_lshl_b32 s80, s92, 1
    s_add_u32 s80, s80, 10
    s_and_b32 s80, s80, 31
    s_mul_i32 s80, s80, 229376
    s_add_u32 m0, s79, 0
    s_mov_b32 exec_hi, 0x00ffffff
    buffer_load_dwordx4 v14, s[44:47], s80 offen offset:0 lds
    buffer_load_dwordx4 v15, s[44:47], s80 offen offset:896 lds
    s_mov_b32 exec_hi, -1
    s_nop 1
    v_lshlrev_b32 v147, 16, v147
    v_sqrt_f32 v147, v147
    s_nop 1
    v_cvt_pk_bf16_f32 v147, v147, v147
    v_lshlrev_b32 v147, 16, v147
    v_rcp_f32 v164, v147
    s_nop 1
    v_mul_f32 v165, v164, v145
    v_cvt_pk_bf16_f32 v149, v149, v149
    v_lshlrev_b32 v149, 16, v149
    v_mul_f32 v149, 0xbfb8aa3b, v149
    v_exp_f32 v149, v149
    s_nop 1
    v_add_f32 v149, 1.0, v149
    v_rcp_f32 v167, v149
    s_nop 1
    v_cvt_pk_bf16_f32 v167, v167, v167
    v_lshlrev_b32 v167, 16, v167
    v_sub_f32 v166, 1.0, v167
    v_cvt_pk_bf16_f32 v166, v166, v166
    v_lshlrev_b32 v166, 16, v166
    v_lshlrev_b32 v88, 16, v88
    v_lshlrev_b32 v89, 16, v89
    v_lshlrev_b32 v90, 16, v90
    v_mul_f32 v90, 0x3fb8aa3b, v90
    v_exp_f32 v90, v90
    s_nop 1
    v_cvt_pk_bf16_f32 v90, v90, v90
    v_lshlrev_b32 v90, 16, v90
    v_mul_f32 v91, v90, v88
    v_mul_f32 v92, v90, v89
    v_mul_f32 v91, 0x3fb8aa3b, v91
    v_mul_f32 v92, 0x3e22f983, v92
    s_waitcnt vmcnt(9)
    s_barrier
    s_add_u32 s80, s92, 5
    s_and_b32 s80, s80, 15
    s_lshl_b32 s80, s80, 7
    s_add_u32 m0, s77, 86016
    s_nop 0
    buffer_load_dwordx4 v8, s[36:39], s80 offen offset:0 lds
    buffer_load_dwordx4 v9, s[36:39], s80 offen offset:1024 lds
    buffer_load_dwordx4 v10, s[36:39], s80 offen offset:2048 lds
    buffer_load_dwordx4 v11, s[36:39], s80 offen offset:3072 lds
    s_add_u32 m0, s78, 81920
    s_nop 0
    buffer_load_dwordx4 v13, s[40:43], s80 offen offset:1024 lds
    s_lshl_b32 s80, s92, 1
    s_add_u32 s80, s80, 11
    s_and_b32 s80, s80, 31
    s_mul_i32 s80, s80, 229376
    s_add_u32 m0, s79, 7168
    s_mov_b32 exec_hi, 0x00ffffff
    buffer_load_dwordx4 v14, s[44:47], s80 offen offset:0 lds
    buffer_load_dwordx4 v15, s[44:47], s80 offen offset:896 lds
    s_mov_b32 exec_hi, -1
    s_nop 1
    v_exp_f32 v91, v91
    v_cos_f32 v93, v92
    v_sin_f32 v94, v92
    s_nop 1
    v_mul_f32 v246, v91, v93
    v_mul_f32 v247, v91, v94
    v_mul_f32 v90, v88, v88
    v_fmac_f32 v90, v89, v89
    v_rcp_f32 v90, v90
    v_add_f32 v91, -1.0, v246
    v_add_f32 v90, v90, v90
    v_mul_f32 v92, v91, v88
    v_fmac_f32 v92, v247, v89
    v_mul_f32 v93, v247, v88
    v_fma_f32 v93, -v91, v89, v93
    v_mul_f32 v248, v92, v90
    v_mul_f32 v249, v93, v90
    v_mov_b32 v24, v246
    v_mov_b32 v25, v247
    v_mul_f32 v152, v24, v24
    v_fma_f32 v152, -v25, v25, v152
    v_mul_f32 v27, v24, v25
    v_add_f32 v27, v27, v27
    v_mov_b32 v26, v152
    v_mul_f32 v152, v26, v26
    v_fma_f32 v152, -v27, v27, v152
    v_mul_f32 v27, v26, v27
    v_add_f32 v27, v27, v27
    v_mov_b32 v26, v152
    v_mul_f32 v152, v26, v26
    v_fma_f32 v152, -v27, v27, v152
    v_mul_f32 v27, v26, v27
    v_add_f32 v27, v27, v27
    s_waitcnt vmcnt(14)
    s_barrier
    s_add_u32 s80, s92, 6
    s_and_b32 s80, s80, 15
    s_lshl_b32 s80, s80, 7
    s_add_u32 m0, s77, 0
    s_nop 0
    buffer_load_dwordx4 v4, s[36:39], s80 offen offset:0 lds
    buffer_load_dwordx4 v5, s[36:39], s80 offen offset:1024 lds
    buffer_load_dwordx4 v6, s[36:39], s80 offen offset:2048 lds
    buffer_load_dwordx4 v7, s[36:39], s80 offen offset:3072 lds
    s_add_u32 m0, s78, 0
    s_nop 0
    buffer_load_dwordx4 v12, s[40:43], s80 offen offset:0 lds
    s_lshl_b32 s80, s92, 1
    s_add_u32 s80, s80, 12
    s_and_b32 s80, s80, 31
    s_mul_i32 s80, s80, 229376
    s_add_u32 m0, s79, 14336
    s_mov_b32 exec_hi, 0x00ffffff
    buffer_load_dwordx4 v14, s[44:47], s80 offen offset:0 lds
    buffer_load_dwordx4 v15, s[44:47], s80 offen offset:896 lds
    s_mov_b32 exec_hi, -1
    s_nop 1
    v_mov_b32 v26, v152
    v_mul_f32 v152, v26, v26
    v_fma_f32 v152, -v27, v27, v152
    v_mul_f32 v27, v26, v27
    v_add_f32 v27, v27, v27
    v_mov_b32 v26, v152
    v_mul_f32 v152, v26, v26
    v_fma_f32 v152, -v27, v27, v152
    v_mul_f32 v29, v26, v27
    v_add_f32 v29, v29, v29
    v_mov_b32 v28, v152
    v_mul_f32 v152, v28, v28
    v_fma_f32 v152, -v29, v29, v152
    v_mul_f32 v29, v28, v29
    v_add_f32 v29, v29, v29
    v_mov_b32 v28, v152
    v_mul_f32 v152, v28, v28
    v_fma_f32 v152, -v29, v29, v152
    v_mul_f32 v29, v28, v29
    v_add_f32 v29, v29, v29
    v_mov_b32 v28, v152
    v_mul_f32 v152, v28, v28
    v_fma_f32 v152, -v29, v29, v152
    v_mul_f32 v29, v28, v29
    v_add_f32 v29, v29, v29
    v_mov_b32 v28, v152
    v_mov_b32 v168, 0
    v_mov_b32 v169, 0
    v_mov_b32 v170, 0
    v_mov_b32 v171, 0
    v_lshlrev_b32 v152, 16, v56
    v_and_b32 v153, 0xffff0000, v56
    v_add_f32 v168, v168, v152
    s_waitcnt vmcnt(9)
    s_barrier
    s_add_u32 s80, s92, 6
    s_and_b32 s80, s80, 15
    s_lshl_b32 s80, s80, 7
    s_add_u32 m0, s77, 4096
    s_nop 0
    buffer_load_dwordx4 v8, s[36:39], s80 offen offset:0 lds
    buffer_load_dwordx4 v9, s[36:39], s80 offen offset:1024 lds
    buffer_load_dwordx4 v10, s[36:39], s80 offen offset:2048 lds
    buffer_load_dwordx4 v11, s[36:39], s80 offen offset:3072 lds
    s_add_u32 m0, s78, 0
    s_nop 0
    buffer_load_dwordx4 v13, s[40:43], s80 offen offset:1024 lds
    s_lshl_b32 s80, s92, 1
    s_add_u32 s80, s80, 13
    s_and_b32 s80, s80, 31
    s_mul_i32 s80, s80, 229376
    s_add_u32 m0, s79, 21504
    s_mov_b32 exec_hi, 0x00ffffff
    buffer_load_dwordx4 v14, s[44:47], s80 offen offset:0 lds
    buffer_load_dwordx4 v15, s[44:47], s80 offen offset:896 lds
    s_mov_b32 exec_hi, -1
    s_nop 1
    v_add_f32 v169, v169, v153
    v_lshlrev_b32 v152, 16, v57
    v_and_b32 v153, 0xffff0000, v57
    v_add_f32 v170, v170, v152
    v_add_f32 v171, v171, v153
    v_lshlrev_b32 v152, 16, v58
    v_and_b32 v153, 0xffff0000, v58
    v_add_f32 v168, v168, v152
    v_add_f32 v169, v169, v153
    v_lshlrev_b32 v152, 16, v59
    v_and_b32 v153, 0xffff0000, v59
    v_add_f32 v170, v170, v152
    v_add_f32 v171, v171, v153
    v_lshlrev_b32 v152, 16, v60
    v_and_b32 v153, 0xffff0000, v60
    v_add_f32 v168, v168, v152
    v_add_f32 v169, v169, v153
    v_lshlrev_b32 v152, 16, v61
    v_and_b32 v153, 0xffff0000, v61
    v_add_f32 v170, v170, v152
    v_add_f32 v171, v171, v153
    v_lshlrev_b32 v152, 16, v62
    v_and_b32 v153, 0xffff0000, v62
    v_add_f32 v168, v168, v152
    v_add_f32 v169, v169, v153
    v_lshlrev_b32 v152, 16, v63
    v_and_b32 v153, 0xffff0000, v63
    v_add_f32 v170, v170, v152
    v_add_f32 v171, v171, v153
    v_lshlrev_b32 v152, 16, v64
    v_and_b32 v153, 0xffff0000, v64
    v_add_f32 v168, v168, v152
    v_add_f32 v169, v169, v153
    s_waitcnt vmcnt(14)
    s_barrier
    s_add_u32 s80, s92, 7
    s_and_b32 s80, s80, 15
    s_lshl_b32 s80, s80, 7
    s_add_u32 m0, s77, 40960
    s_nop 0
    buffer_load_dwordx4 v4, s[36:39], s80 offen offset:0 lds
    buffer_load_dwordx4 v5, s[36:39], s80 offen offset:1024 lds
    buffer_load_dwordx4 v6, s[36:39], s80 offen offset:2048 lds
    buffer_load_dwordx4 v7, s[36:39], s80 offen offset:3072 lds
    s_add_u32 m0, s78, 40960
    s_nop 0
    buffer_load_dwordx4 v12, s[40:43], s80 offen offset:0 lds
    s_lshl_b32 s80, s92, 1
    s_add_u32 s80, s80, 14
    s_and_b32 s80, s80, 31
    s_mul_i32 s80, s80, 229376
    s_add_u32 m0, s79, 28672
    s_mov_b32 exec_hi, 0x00ffffff
    buffer_load_dwordx4 v14, s[44:47], s80 offen offset:0 lds
    buffer_load_dwordx4 v15, s[44:47], s80 offen offset:896 lds
    s_mov_b32 exec_hi, -1
    s_nop 1
    v_lshlrev_b32 v152, 16, v65
    v_and_b32 v153, 0xffff0000, v65
    v_add_f32 v170, v170, v152
    v_add_f32 v171, v171, v153
    v_lshlrev_b32 v152, 16, v66
    v_and_b32 v153, 0xffff0000, v66
    v_add_f32 v168, v168, v152
    v_add_f32 v169, v169, v153
    v_lshlrev_b32 v152, 16, v67
    v_and_b32 v153, 0xffff0000, v67
    v_add_f32 v170, v170, v152
    v_add_f32 v171, v171, v153
    v_lshlrev_b32 v152, 16, v68
    v_and_b32 v153, 0xffff0000, v68
    v_add_f32 v168, v168, v152
    v_add_f32 v169, v169, v153
    v_lshlrev_b32 v152, 16, v69
    v_and_b32 v153, 0xffff0000, v69
    v_add_f32 v170, v170, v152
    v_add_f32 v171, v171, v153
    v_lshlrev_b32 v152, 16, v70
    v_and_b32 v153, 0xffff0000, v70
    v_add_f32 v168, v168, v152
    v_add_f32 v169, v169, v153
    v_lshlrev_b32 v152, 16, v71
    v_and_b32 v153, 0xffff0000, v71
    v_add_f32 v170, v170, v152
    v_add_f32 v171, v171, v153
    v_lshlrev_b32 v152, 16, v72
    v_and_b32 v153, 0xffff0000, v72
    v_add_f32 v168, v168, v152
    v_add_f32 v169, v169, v153
    v_lshlrev_b32 v152, 16, v73
    s_waitcnt vmcnt(9)
    s_barrier
    s_add_u32 s80, s92, 7
    s_and_b32 s80, s80, 15
    s_lshl_b32 s80, s80, 7
    s_add_u32 m0, s77, 45056
    s_nop 0
    buffer_load_dwordx4 v8, s[36:39], s80 offen offset:0 lds
    buffer_load_dwordx4 v9, s[36:39], s80 offen offset:1024 lds
    buffer_load_dwordx4 v10, s[36:39], s80 offen offset:2048 lds
    buffer_load_dwordx4 v11, s[36:39], s80 offen offset:3072 lds
    s_add_u32 m0, s78, 40960
    s_nop 0
    buffer_load_dwordx4 v13, s[40:43], s80 offen offset:1024 lds
    s_lshl_b32 s80, s92, 1
    s_add_u32 s80, s80, 15
    s_and_b32 s80, s80, 31
    s_mul_i32 s80, s80, 229376
    s_add_u32 m0, s79, 0
    s_mov_b32 exec_hi, 0x00ffffff
    buffer_load_dwordx4 v14, s[44:47], s80 offen offset:0 lds
    buffer_load_dwordx4 v15, s[44:47], s80 offen offset:896 lds
    s_mov_b32 exec_hi, -1
    s_nop 1
    v_and_b32 v153, 0xffff0000, v73
    v_add_f32 v170, v170, v152
    v_add_f32 v171, v171, v153
    v_lshlrev_b32 v152, 16, v74
    v_and_b32 v153, 0xffff0000, v74
    v_add_f32 v168, v168, v152
    v_add_f32 v169, v169, v153
    v_lshlrev_b32 v152, 16, v75
    v_and_b32 v153, 0xffff0000, v75
    v_add_f32 v170, v170, v152
    v_add_f32 v171, v171, v153
    v_lshlrev_b32 v152, 16, v76
    v_and_b32 v153, 0xffff0000, v76
    v_add_f32 v168, v168, v152
    v_add_f32 v169, v169, v153
    v_lshlrev_b32 v152, 16, v77
    v_and_b32 v153, 0xffff0000, v77
    v_add_f32 v170, v170, v152
    v_add_f32 v171, v171, v153
    v_lshlrev_b32 v152, 16, v78
    v_and_b32 v153, 0xffff0000, v78
    v_add_f32 v168, v168, v152
    v_add_f32 v169, v169, v153
    v_lshlrev_b32 v152, 16, v79
    v_and_b32 v153, 0xffff0000, v79
    v_add_f32 v170, v170, v152
    v_add_f32 v171, v171, v153
    v_lshlrev_b32 v152, 16, v80
    v_and_b32 v153, 0xffff0000, v80
    v_add_f32 v168, v168, v152
    v_add_f32 v169, v169, v153
    v_lshlrev_b32 v152, 16, v81
    v_and_b32 v153, 0xffff0000, v81
    s_waitcnt vmcnt(14)
    s_barrier
    s_add_u32 s80, s92, 8
    s_and_b32 s80, s80, 15
    s_lshl_b32 s80, s80, 7
    s_add_u32 m0, s77, 81920
    s_nop 0
    buffer_load_dwordx4 v4, s[36:39], s80 offen offset:0 lds
    buffer_load_dwordx4 v5, s[36:39], s80 offen offset:1024 lds
    buffer_load_dwordx4 v6, s[36:39], s80 offen offset:2048 lds
    buffer_load_dwordx4 v7, s[36:39], s80 offen offset:3072 lds
    s_add_u32 m0, s78, 81920
    s_nop 0
    buffer_load_dwordx4 v12, s[40:43], s80 offen offset:0 lds
    s_lshl_b32 s80, s92, 1
    s_add_u32 s80, s80, 16
    s_and_b32 s80, s80, 31
    s_mul_i32 s80, s80, 229376
    s_add_u32 m0, s79, 7168
    s_mov_b32 exec_hi, 0x00ffffff
    buffer_load_dwordx4 v14, s[44:47], s80 offen offset:0 lds
    buffer_load_dwordx4 v15, s[44:47], s80 offen offset:896 lds
    s_mov_b32 exec_hi, -1
    s_nop 1
    v_add_f32 v170, v170, v152
    v_add_f32 v171, v171, v153
    v_lshlrev_b32 v152, 16, v82
    v_and_b32 v153, 0xffff0000, v82
    v_add_f32 v168, v168, v152
    v_add_f32 v169, v169, v153
    v_lshlrev_b32 v152, 16, v83
    v_and_b32 v153, 0xffff0000, v83
    v_add_f32 v170, v170, v152
    v_add_f32 v171, v171, v153
    v_lshlrev_b32 v152, 16, v84
    v_and_b32 v153, 0xffff0000, v84
    v_add_f32 v168, v168, v152
    v_add_f32 v169, v169, v153
    v_lshlrev_b32 v152, 16, v85
    v_and_b32 v153, 0xffff0000, v85
    v_add_f32 v170, v170, v152
    v_add_f32 v171, v171, v153
    v_lshlrev_b32 v152, 16, v86
    v_and_b32 v153, 0xffff0000, v86
    v_add_f32 v168, v168, v152
    v_add_f32 v169, v169, v153
    v_lshlrev_b32 v152, 16, v87
    v_and_b32 v153, 0xffff0000, v87
    v_add_f32 v170, v170, v152
    v_add_f32 v171, v171, v153
    s_nop 1
    v_add_f32_dpp v168, v168, v168 row_ror:8 row_mask:0xf bank_mask:0xf
    v_add_f32_dpp v169, v169, v169 row_ror:8 row_mask:0xf bank_mask:0xf
    v_add_f32_dpp v170, v170, v170 row_ror:8 row_mask:0xf bank_mask:0xf
    v_add_f32_dpp v171, v171, v171 row_ror:8 row_mask:0xf bank_mask:0xf
    v_mov_b32 v152, v168
    v_mov_b32 v153, v169
    s_waitcnt vmcnt(9)
    s_barrier
    s_add_u32 s80, s92, 8
    s_and_b32 s80, s80, 15
    s_lshl_b32 s80, s80, 7
    s_add_u32 m0, s77, 86016
    s_nop 0
    buffer_load_dwordx4 v8, s[36:39], s80 offen offset:0 lds
    buffer_load_dwordx4 v9, s[36:39], s80 offen offset:1024 lds
    buffer_load_dwordx4 v10, s[36:39], s80 offen offset:2048 lds
    buffer_load_dwordx4 v11, s[36:39], s80 offen offset:3072 lds
    s_add_u32 m0, s78, 81920
    s_nop 0
    buffer_load_dwordx4 v13, s[40:43], s80 offen offset:1024 lds
    s_lshl_b32 s80, s92, 1
    s_add_u32 s80, s80, 17
    s_and_b32 s80, s80, 31
    s_mul_i32 s80, s80, 229376
    s_add_u32 m0, s79, 14336
    s_mov_b32 exec_hi, 0x00ffffff
    buffer_load_dwordx4 v14, s[44:47], s80 offen offset:0 lds
    buffer_load_dwordx4 v15, s[44:47], s80 offen offset:896 lds
    s_mov_b32 exec_hi, -1
    s_nop 1
    v_mov_b32 v154, v170
    v_mov_b32 v155, v171
    s_nop 1
    v_permlane16_swap_b32 v168, v152
    v_permlane16_swap_b32 v169, v153
    v_permlane16_swap_b32 v170, v154
    v_permlane16_swap_b32 v171, v155
    s_nop 1
    v_add_f32 v168, v168, v152
    v_add_f32 v169, v169, v153
    v_add_f32 v170, v170, v154
    v_add_f32 v171, v171, v155
    v_mov_b32 v152, v168
    v_mov_b32 v153, v169
    v_mov_b32 v154, v170
    v_mov_b32 v155, v171
    s_nop 1
    v_permlane32_swap_b32 v168, v152
    v_permlane32_swap_b32 v169, v153
    v_permlane32_swap_b32 v170, v154
    v_permlane32_swap_b32 v171, v155
    s_nop 1
    v_add_f32 v168, v168, v152
    v_add_f32 v169, v169, v153
    v_add_f32 v170, v170, v154
    v_add_f32 v171, v171, v155
    s_lshl_b32 s71, s74, 4
    s_add_u32 s71, s71, 34603008
    v_mov_b32 v19, 0
    s_mov_b64 exec, 1
    buffer_store_dwordx4 v[160:163], v19, s[48:51], s71 offen offset:0 sc0 sc1
    buffer_store_dwordx4 v[164:167], v19, s[48:51], s71 offen offset:16 sc0 sc1
    s_lshl_b32 s71, s70, 3
    s_add_u32 s71, s71, s69
    s_mul_i32 s71, s71, 448
    s_mul_i32 s72, s68, 112
    s_add_u32 s71, s71, s72
    s_add_u32 s71, s71, 35651584
    s_mov_b64 exec, 0x7f
    buffer_store_dwordx4 v[168:171], v21, s[48:51], s71 offen sc0 sc1
    s_mov_b64 exec, -1
    s_lshl_b32 s71, s83, 8
    s_add_u32 s71, s71, 36700160
    buffer_store_dword v200, v22, s[48:51], s71 offen sc0 sc1
    v_lshlrev_b32 v20, 12, v1
    s_mov_b64 exec, 3
    s_lshl_b32 s71, s69, 2
    s_add_u32 s71, s71, s68
    s_lshl_b32 s71, s71, 5
    s_add_u32 s71, s71, s70
    s_lshl_b32 s71, s71, 2
    s_add_u32 s71, s71, 33554432
    buffer_store_dword v19, v20, s[48:51], s71 offen sc0 sc1
    s_mov_b64 exec, -1
    s_waitcnt vmcnt(19)
    s_barrier
    s_add_u32 s80, s92, 9
    s_and_b32 s80, s80, 15
    s_lshl_b32 s80, s80, 7
    s_add_u32 m0, s77, 0
    s_nop 0
    buffer_load_dwordx4 v4, s[36:39], s80 offen offset:0 lds
    buffer_load_dwordx4 v5, s[36:39], s80 offen offset:1024 lds
    buffer_load_dwordx4 v6, s[36:39], s80 offen offset:2048 lds
    buffer_load_dwordx4 v7, s[36:39], s80 offen offset:3072 lds
    s_add_u32 m0, s78, 0
    s_nop 0
    buffer_load_dwordx4 v12, s[40:43], s80 offen offset:0 lds
    s_lshl_b32 s80, s92, 1
    s_add_u32 s80, s80, 18
    s_and_b32 s80, s80, 31
    s_mul_i32 s80, s80, 229376
    s_add_u32 m0, s79, 21504
    s_mov_b32 exec_hi, 0x00ffffff
    buffer_load_dwordx4 v14, s[44:47], s80 offen offset:0 lds
    buffer_load_dwordx4 v15, s[44:47], s80 offen offset:896 lds
    s_mov_b32 exec_hi, -1
    s_waitcnt vmcnt(14)
    s_barrier
    s_add_u32 s80, s92, 9
    s_and_b32 s80, s80, 15
    s_lshl_b32 s80, s80, 7
    s_add_u32 m0, s77, 4096
    s_nop 0
    buffer_load_dwordx4 v8, s[36:39], s80 offen offset:0 lds
    buffer_load_dwordx4 v9, s[36:39], s80 offen offset:1024 lds
    buffer_load_dwordx4 v10, s[36:39], s80 offen offset:2048 lds
    buffer_load_dwordx4 v11, s[36:39], s80 offen offset:3072 lds
    s_add_u32 m0, s78, 0
    s_nop 0
    buffer_load_dwordx4 v13, s[40:43], s80 offen offset:1024 lds
    s_lshl_b32 s80, s92, 1
    s_add_u32 s80, s80, 19
    s_and_b32 s80, s80, 31
    s_mul_i32 s80, s80, 229376
    s_add_u32 m0, s79, 28672
    s_mov_b32 exec_hi, 0x00ffffff
    buffer_load_dwordx4 v14, s[44:47], s80 offen offset:0 lds
    buffer_load_dwordx4 v15, s[44:47], s80 offen offset:896 lds
    s_mov_b32 exec_hi, -1
    s_waitcnt vmcnt(14)
    s_barrier
    s_add_u32 s80, s92, 10
    s_and_b32 s80, s80, 15
    s_lshl_b32 s80, s80, 7
    s_add_u32 m0, s77, 40960
    s_nop 0
    buffer_load_dwordx4 v4, s[36:39], s80 offen offset:0 lds
    buffer_load_dwordx4 v5, s[36:39], s80 offen offset:1024 lds
    buffer_load_dwordx4 v6, s[36:39], s80 offen offset:2048 lds
    buffer_load_dwordx4 v7, s[36:39], s80 offen offset:3072 lds
    s_add_u32 m0, s78, 40960
    s_nop 0
    buffer_load_dwordx4 v12, s[40:43], s80 offen offset:0 lds
    s_lshl_b32 s80, s92, 1
    s_add_u32 s80, s80, 20
    s_and_b32 s80, s80, 31
    s_mul_i32 s80, s80, 229376
    s_add_u32 m0, s79, 0
    s_mov_b32 exec_hi, 0x00ffffff
    buffer_load_dwordx4 v14, s[44:47], s80 offen offset:0 lds
    buffer_load_dwordx4 v15, s[44:47], s80 offen offset:896 lds
    s_mov_b32 exec_hi, -1
    s_waitcnt vmcnt(9)
    s_barrier
    s_add_u32 s80, s92, 10
    s_and_b32 s80, s80, 15
    s_lshl_b32 s80, s80, 7
    s_add_u32 m0, s77, 45056
    s_nop 0
    buffer_load_dwordx4 v8, s[36:39], s80 offen offset:0 lds
    buffer_load_dwordx4 v9, s[36:39], s80 offen offset:1024 lds
    buffer_load_dwordx4 v10, s[36:39], s80 offen offset:2048 lds
    buffer_load_dwordx4 v11, s[36:39], s80 offen offset:3072 lds
    s_add_u32 m0, s78, 40960
    s_nop 0
    buffer_load_dwordx4 v13, s[40:43], s80 offen offset:1024 lds
    s_lshl_b32 s80, s92, 1
    s_add_u32 s80, s80, 21
    s_and_b32 s80, s80, 31
    s_mul_i32 s80, s80, 229376
    s_add_u32 m0, s79, 7168
    s_mov_b32 exec_hi, 0x00ffffff
    buffer_load_dwordx4 v14, s[44:47], s80 offen offset:0 lds
    buffer_load_dwordx4 v15, s[44:47], s80 offen offset:896 lds
    s_mov_b32 exec_hi, -1
    s_waitcnt vmcnt(14)
    s_barrier
    s_add_u32 s80, s92, 11
    s_and_b32 s80, s80, 15
    s_lshl_b32 s80, s80, 7
    s_add_u32 m0, s77, 81920
    s_nop 0
    buffer_load_dwordx4 v4, s[36:39], s80 offen offset:0 lds
    buffer_load_dwordx4 v5, s[36:39], s80 offen offset:1024 lds
    buffer_load_dwordx4 v6, s[36:39], s80 offen offset:2048 lds
    buffer_load_dwordx4 v7, s[36:39], s80 offen offset:3072 lds
    s_add_u32 m0, s78, 81920
    s_nop 0
    buffer_load_dwordx4 v12, s[40:43], s80 offen offset:0 lds
    s_lshl_b32 s80, s92, 1
    s_add_u32 s80, s80, 22
    s_and_b32 s80, s80, 31
    s_mul_i32 s80, s80, 229376
    s_add_u32 m0, s79, 14336
    s_mov_b32 exec_hi, 0x00ffffff
    buffer_load_dwordx4 v14, s[44:47], s80 offen offset:0 lds
    buffer_load_dwordx4 v15, s[44:47], s80 offen offset:896 lds
    s_mov_b32 exec_hi, -1
    s_waitcnt vmcnt(9)
    s_barrier
    s_add_u32 s80, s92, 11
    s_and_b32 s80, s80, 15
    s_lshl_b32 s80, s80, 7
    s_add_u32 m0, s77, 86016
    s_nop 0
    buffer_load_dwordx4 v8, s[36:39], s80 offen offset:0 lds
    buffer_load_dwordx4 v9, s[36:39], s80 offen offset:1024 lds
    buffer_load_dwordx4 v10, s[36:39], s80 offen offset:2048 lds
    buffer_load_dwordx4 v11, s[36:39], s80 offen offset:3072 lds
    s_add_u32 m0, s78, 81920
    s_nop 0
    buffer_load_dwordx4 v13, s[40:43], s80 offen offset:1024 lds
    s_lshl_b32 s80, s92, 1
    s_add_u32 s80, s80, 23
    s_and_b32 s80, s80, 31
    s_mul_i32 s80, s80, 229376
    s_add_u32 m0, s79, 21504
    s_mov_b32 exec_hi, 0x00ffffff
    buffer_load_dwordx4 v14, s[44:47], s80 offen offset:0 lds
    buffer_load_dwordx4 v15, s[44:47], s80 offen offset:896 lds
    s_mov_b32 exec_hi, -1
    s_waitcnt vmcnt(14)
    s_barrier
    s_add_u32 s80, s92, 12
    s_and_b32 s80, s80, 15
    s_lshl_b32 s80, s80, 7
    s_add_u32 m0, s77, 0
    s_nop 0
    buffer_load_dwordx4 v4, s[36:39], s80 offen offset:0 lds
    buffer_load_dwordx4 v5, s[36:39], s80 offen offset:1024 lds
    buffer_load_dwordx4 v6, s[36:39], s80 offen offset:2048 lds
    buffer_load_dwordx4 v7, s[36:39], s80 offen offset:3072 lds
    s_add_u32 m0, s78, 0
    s_nop 0
    buffer_load_dwordx4 v12, s[40:43], s80 offen offset:0 lds
    s_lshl_b32 s80, s92, 1
    s_add_u32 s80, s80, 24
    s_and_b32 s80, s80, 31
    s_mul_i32 s80, s80, 229376
    s_add_u32 m0, s79, 28672
    s_mov_b32 exec_hi, 0x00ffffff
    buffer_load_dwordx4 v14, s[44:47], s80 offen offset:0 lds
    buffer_load_dwordx4 v15, s[44:47], s80 offen offset:896 lds
    s_mov_b32 exec_hi, -1
    s_waitcnt vmcnt(9)
    s_barrier
    s_add_u32 s80, s92, 12
    s_and_b32 s80, s80, 15
    s_lshl_b32 s80, s80, 7
    s_add_u32 m0, s77, 4096
    s_nop 0
    buffer_load_dwordx4 v8, s[36:39], s80 offen offset:0 lds
    buffer_load_dwordx4 v9, s[36:39], s80 offen offset:1024 lds
    buffer_load_dwordx4 v10, s[36:39], s80 offen offset:2048 lds
    buffer_load_dwordx4 v11, s[36:39], s80 offen offset:3072 lds
    s_add_u32 m0, s78, 0
    s_nop 0
    buffer_load_dwordx4 v13, s[40:43], s80 offen offset:1024 lds
    s_lshl_b32 s80, s92, 1
    s_add_u32 s80, s80, 25
    s_and_b32 s80, s80, 31
    s_mul_i32 s80, s80, 229376
    s_add_u32 m0, s79, 0
    s_mov_b32 exec_hi, 0x00ffffff
    buffer_load_dwordx4 v14, s[44:47], s80 offen offset:0 lds
    buffer_load_dwordx4 v15, s[44:47], s80 offen offset:896 lds
    s_mov_b32 exec_hi, -1
    s_waitcnt vmcnt(14)
    s_barrier
    s_add_u32 s80, s92, 13
    s_and_b32 s80, s80, 15
    s_lshl_b32 s80, s80, 7
    s_add_u32 m0, s77, 40960
    s_nop 0
    buffer_load_dwordx4 v4, s[36:39], s80 offen offset:0 lds
    buffer_load_dwordx4 v5, s[36:39], s80 offen offset:1024 lds
    buffer_load_dwordx4 v6, s[36:39], s80 offen offset:2048 lds
    buffer_load_dwordx4 v7, s[36:39], s80 offen offset:3072 lds
    s_add_u32 m0, s78, 40960
    s_nop 0
    buffer_load_dwordx4 v12, s[40:43], s80 offen offset:0 lds
    s_lshl_b32 s80, s92, 1
    s_add_u32 s80, s80, 26
    s_and_b32 s80, s80, 31
    s_mul_i32 s80, s80, 229376
    s_add_u32 m0, s79, 7168
    s_mov_b32 exec_hi, 0x00ffffff
    buffer_load_dwordx4 v14, s[44:47], s80 offen offset:0 lds
    buffer_load_dwordx4 v15, s[44:47], s80 offen offset:896 lds
    s_mov_b32 exec_hi, -1
    s_waitcnt vmcnt(9)
    s_barrier
    s_add_u32 s80, s92, 13
    s_and_b32 s80, s80, 15
    s_lshl_b32 s80, s80, 7
    s_add_u32 m0, s77, 45056
    s_nop 0
    buffer_load_dwordx4 v8, s[36:39], s80 offen offset:0 lds
    buffer_load_dwordx4 v9, s[36:39], s80 offen offset:1024 lds
    buffer_load_dwordx4 v10, s[36:39], s80 offen offset:2048 lds
    buffer_load_dwordx4 v11, s[36:39], s80 offen offset:3072 lds
    s_add_u32 m0, s78, 40960
    s_nop 0
    buffer_load_dwordx4 v13, s[40:43], s80 offen offset:1024 lds
    s_lshl_b32 s80, s92, 1
    s_add_u32 s80, s80, 27
    s_and_b32 s80, s80, 31
    s_mul_i32 s80, s80, 229376
    s_add_u32 m0, s79, 14336
    s_mov_b32 exec_hi, 0x00ffffff
    buffer_load_dwordx4 v14, s[44:47], s80 offen offset:0 lds
    buffer_load_dwordx4 v15, s[44:47], s80 offen offset:896 lds
    s_mov_b32 exec_hi, -1
    s_waitcnt vmcnt(14)
    s_barrier
    s_add_u32 s80, s92, 14
    s_and_b32 s80, s80, 15
    s_lshl_b32 s80, s80, 7
    s_add_u32 m0, s77, 81920
    s_nop 0
    buffer_load_dwordx4 v4, s[36:39], s80 offen offset:0 lds
    buffer_load_dwordx4 v5, s[36:39], s80 offen offset:1024 lds
    buffer_load_dwordx4 v6, s[36:39], s80 offen offset:2048 lds
    buffer_load_dwordx4 v7, s[36:39], s80 offen offset:3072 lds
    s_add_u32 m0, s78, 81920
    s_nop 0
    buffer_load_dwordx4 v12, s[40:43], s80 offen offset:0 lds
    s_lshl_b32 s80, s92, 1
    s_add_u32 s80, s80, 28
    s_and_b32 s80, s80, 31
    s_mul_i32 s80, s80, 229376
    s_add_u32 m0, s79, 21504
    s_mov_b32 exec_hi, 0x00ffffff
    buffer_load_dwordx4 v14, s[44:47], s80 offen offset:0 lds
    buffer_load_dwordx4 v15, s[44:47], s80 offen offset:896 lds
    s_mov_b32 exec_hi, -1
    buffer_load_dword v204, v22, s[52:55], 0 offen sc0 sc1
    s_and_b32 s71, s70, 3
    s_lshl_b32 s71, s71, 3
    s_lshl_b32 s71, 1, s71
    s_lshr_b32 s72, s70, 2
    v_mov_b32 v205, 0
    v_mov_b32 v19, s71
    v_cmp_eq_u32 vcc, s72, v17
    v_cndmask_b32 v205, v205, v19, vcc
    v_mov_b32 v19, 0x01010101
    v_cmp_eq_u32 vcc, s69, v16
    v_cndmask_b32 v205, v205, v19, vcc
    v_mov_b32 v205, 0x01010101
    s_waitcnt vmcnt(10)
    s_barrier
    s_add_u32 s80, s92, 14
    s_and_b32 s80, s80, 15
    s_lshl_b32 s80, s80, 7
    s_add_u32 m0, s77, 86016
    s_nop 0
    buffer_load_dwordx4 v8, s[36:39], s80 offen offset:0 lds
    buffer_load_dwordx4 v9, s[36:39], s80 offen offset:1024 lds
    buffer_load_dwordx4 v10, s[36:39], s80 offen offset:2048 lds
    buffer_load_dwordx4 v11, s[36:39], s80 offen offset:3072 lds
    s_add_u32 m0, s78, 81920
    s_nop 0
    buffer_load_dwordx4 v13, s[40:43], s80 offen offset:1024 lds
    s_lshl_b32 s80, s92, 1
    s_add_u32 s80, s80, 29
    s_and_b32 s80, s80, 31
    s_mul_i32 s80, s80, 229376
    s_add_u32 m0, s79, 28672
    s_mov_b32 exec_hi, 0x00ffffff
    buffer_load_dwordx4 v14, s[44:47], s80 offen offset:0 lds
    buffer_load_dwordx4 v15, s[44:47], s80 offen offset:896 lds
    s_mov_b32 exec_hi, -1
    s_waitcnt vmcnt(15)
    s_barrier
    s_add_u32 s80, s92, 15
    s_and_b32 s80, s80, 15
    s_lshl_b32 s80, s80, 7
    s_add_u32 m0, s77, 0
    s_nop 0
    buffer_load_dwordx4 v4, s[36:39], s80 offen offset:0 lds
    buffer_load_dwordx4 v5, s[36:39], s80 offen offset:1024 lds
    buffer_load_dwordx4 v6, s[36:39], s80 offen offset:2048 lds
    buffer_load_dwordx4 v7, s[36:39], s80 offen offset:3072 lds
    s_add_u32 m0, s78, 0
    s_nop 0
    buffer_load_dwordx4 v12, s[40:43], s80 offen offset:0 lds
    s_lshl_b32 s80, s92, 1
    s_add_u32 s80, s80, 30
    s_and_b32 s80, s80, 31
    s_mul_i32 s80, s80, 229376
    s_add_u32 m0, s79, 0
    s_mov_b32 exec_hi, 0x00ffffff
    buffer_load_dwordx4 v14, s[44:47], s80 offen offset:0 lds
    buffer_load_dwordx4 v15, s[44:47], s80 offen offset:896 lds
    s_mov_b32 exec_hi, -1
    s_waitcnt vmcnt(9)
    s_barrier
    s_add_u32 s80, s92, 15
    s_and_b32 s80, s80, 15
    s_lshl_b32 s80, s80, 7
    s_add_u32 m0, s77, 4096
    s_nop 0
    buffer_load_dwordx4 v8, s[36:39], s80 offen offset:0 lds
    buffer_load_dwordx4 v9, s[36:39], s80 offen offset:1024 lds
    buffer_load_dwordx4 v10, s[36:39], s80 offen offset:2048 lds
    buffer_load_dwordx4 v11, s[36:39], s80 offen offset:3072 lds
    s_add_u32 m0, s78, 0
    s_nop 0
    buffer_load_dwordx4 v13, s[40:43], s80 offen offset:1024 lds
    s_lshl_b32 s80, s92, 1
    s_add_u32 s80, s80, 31
    s_and_b32 s80, s80, 31
    s_mul_i32 s80, s80, 229376
    s_add_u32 m0, s79, 7168
    s_mov_b32 exec_hi, 0x00ffffff
    buffer_load_dwordx4 v14, s[44:47], s80 offen offset:0 lds
    buffer_load_dwordx4 v15, s[44:47], s80 offen offset:896 lds
    s_mov_b32 exec_hi, -1
    s_mov_b32 s75, 30000
L_k1_kernel_poll:
    v_and_b32 v19, v204, v205
    v_cmp_ne_u32 vcc, v19, v205
    s_cmp_eq_u64 vcc, 0
    s_cbranch_scc1 L_k1_kernel_pok
    buffer_load_dword v204, v22, s[52:55], 0 offen sc0 sc1
    s_waitcnt vmcnt(0)
    s_sub_u32 s75, s75, 1
    s_cmp_lg_u32 s75, 0
    s_cbranch_scc1 L_k1_kernel_poll
L_k1_kernel_pok:
    s_lshl_b32 s71, s82, 4
    s_add_u32 s71, s71, 34603008
    buffer_load_dwordx4 v[208:211], v21, s[48:51], s71 offen sc0 sc1
    s_mul_i32 s71, s70, 3584
    s_add_u32 s71, s71, 35651584
    s_mov_b32 s56, s22
    s_and_b32 s57, s23, 0xffff
    s_mov_b32 s58, 7168
    s_mov_b32 s59, 0x20000
    s_mov_b64 exec, 0xfffffff
    v_lshlrev_b32 v19, 3, v1
    s_mul_i32 s72, s70, 224
    buffer_load_dwordx4 v[212:215], v21, s[48:51], s71 offen offset:0 sc0 sc1
    buffer_load_dwordx4 v[216:219], v21, s[48:51], s71 offen offset:448 sc0 sc1
    buffer_load_dwordx4 v[220:223], v21, s[48:51], s71 offen offset:896 sc0 sc1
    buffer_load_dwordx4 v[224:227], v21, s[48:51], s71 offen offset:1344 sc0 sc1
    buffer_load_dwordx4 v[228:231], v21, s[48:51], s71 offen offset:1792 sc0 sc1
    buffer_load_dwordx4 v[232:235], v21, s[48:51], s71 offen offset:2240 sc0 sc1
    buffer_load_dwordx4 v[236:239], v21, s[48:51], s71 offen offset:2688 sc0 sc1
    buffer_load_dwordx4 v[240:243], v21, s[48:51], s71 offen offset:3136 sc0 sc1
    buffer_load_dwordx2 v[244:245], v19, s[56:59], s72 offen
    s_mov_b64 exec, -1
    s_waitcnt vmcnt(24)
    s_barrier
    s_mov_b32 s56, s24
    s_and_b32 s57, s25, 0xffff
    s_mov_b32 s58, 7340032
    s_mov_b32 s59, 0x20000
    s_mov_b32 s60, s14
    s_and_b32 s61, s15, 0xffff
    s_mov_b32 s62, 2097152
    s_mov_b32 s63, 0x20000
    s_mov_b32 s64, s16
    s_and_b32 s65, s17, 0xffff
    s_mov_b32 s66, 2097152
    s_mov_b32 s67, 0x20000
    s_lshl_b32 s71, s2, 2
    s_add_u32 s71, s71, s68
    s_mul_i32 s72, s71, 7168
    s_lshl_b32 s71, s71, 11
    v_lshlrev_b32 v207, 7, v1
    v_lshlrev_b32 v199, 7, v2
    buffer_load_dword v198, v207, s[56:59], s72 offen
    buffer_load_dword v198, v199, s[60:63], s71 offen
    buffer_load_dword v198, v199, s[64:67], s71 offen
    s_waitcnt vmcnt(15)
    s_barrier
    s_waitcnt vmcnt(3)
    s_barrier
    v_lshrrev_b32 v19, 2, v1
    v_and_b32 v19, 3, v19
    v_lshlrev_b32 v19, 4, v19
    v_lshlrev_b32 v20, 2, v3
    v_add_u32 v19, v19, v20
    v_and_b32 v20, 3, v1
    v_add_u32 v19, v19, v20
    v_lshlrev_b32 v19, 2, v19
    s_lshl_b32 s71, s68, 8
    s_add_u32 s71, s71, 158720
    v_add_u32 v19, s71, v19
    ds_write_b32 v19, v208 offset:0
    ds_write_b32 v19, v209 offset:1024
    ds_write_b32 v19, v211 offset:2048
    v_and_b32 v19, 31, v1
    v_lshlrev_b32 v19, 4, v19
    v_add_u32 v19, 161792, v19
    v_mov_b32 v252, v246
    v_mov_b32 v253, v247
    v_mov_b32 v254, v248
    v_mov_b32 v255, v249
    ds_write_b128 v19, v[252:255]
    v_add_f32 v212, v212, v216
    v_add_f32 v213, v213, v217
    v_add_f32 v214, v214, v218
    v_add_f32 v215, v215, v219
    v_add_f32 v212, v212, v220
    v_add_f32 v213, v213, v221
    v_add_f32 v214, v214, v222
    v_add_f32 v215, v215, v223
    v_add_f32 v212, v212, v224
    v_add_f32 v213, v213, v225
    v_add_f32 v214, v214, v226
    v_add_f32 v215, v215, v227
    v_add_f32 v212, v212, v228
    v_add_f32 v213, v213, v229
    v_add_f32 v214, v214, v230
    v_add_f32 v215, v215, v231
    v_add_f32 v212, v212, v232
    v_add_f32 v213, v213, v233
    v_add_f32 v214, v214, v234
    v_add_f32 v215, v215, v235
    v_add_f32 v212, v212, v236
    v_add_f32 v213, v213, v237
    v_add_f32 v214, v214, v238
    v_add_f32 v215, v215, v239
    v_add_f32 v212, v212, v240
    v_add_f32 v213, v213, v241
    v_add_f32 v214, v214, v242
    v_add_f32 v215, v215, v243
    v_lshlrev_b32 v216, 16, v244
    v_and_b32 v217, 0xffff0000, v244
    v_lshlrev_b32 v218, 16, v245
    v_and_b32 v219, 0xffff0000, v245
    v_subrev_u32 v19, 64, v21
    v_add_u32 v20, 384, v21
    v_cmp_gt_u32 vcc, 4, v1
    v_cndmask_b32 v19, v19, v20, vcc
    s_cmp_eq_u32 s76, 0
    s_cselect_b64 vcc, -1, 0
    v_cndmask_b32 v19, v19, v21, vcc
    v_add_u32 v19, 162816, v19
    s_mov_b64 exec, 0xfffffff
    ds_write_b128 v19, v[212:215]
    ds_write_b128 v19, v[216:219] offset:448
    s_mov_b64 exec, -1
    s_waitcnt lgkmcnt(0)
    s_barrier
    s_barrier
    s_load_dwordx2 s[28:29], s[0:1], 0
    s_load_dwordx2 s[30:31], s[0:1], 64
    s_and_b32 s10, s2, 7
    s_lshr_b32 s11, s2, 3
    s_and_b32 s4, s10, 1
    s_lshr_b32 s10, s10, 1
    s_lshl_b32 s10, s10, 2
    s_and_b32 s12, s11, 3
    s_add_u32 s5, s10, s12
    s_lshr_b32 s6, s11, 2
    s_mul_i32 s7, s4, 28
    v_lshrrev_b32 v20, 4, v1
    v_and_b32 v21, 15, v1
    v_lshrrev_b32 v22, 1, v21
    v_and_b32 v23, 1, v21
    v_lshlrev_b32 v23, 4, v23
    s_lshl_b32 s11, s68, 4
    s_add_u32 s12, s11, 0
    v_add_u32 v24, s12, v20
    v_and_b32 v25, 7, v24
    v_xor_b32 v25, v25, v22
    v_lshlrev_b32 v25, 5, v25
    v_lshlrev_b32 v24, 11, v24
    v_add_u32 v24, v24, v25
    v_add_u32 v24, v24, v23
    v_subrev_u32 v6, 0, v24
    s_add_u32 s12, s11, 4
    v_add_u32 v24, s12, v20
    v_and_b32 v25, 7, v24
    v_xor_b32 v25, v25, v22
    v_lshlrev_b32 v25, 5, v25
    v_lshlrev_b32 v24, 11, v24
    v_add_u32 v24, v24, v25
    v_add_u32 v24, v24, v23
    v_subrev_u32 v7, 1024, v24
    s_add_u32 s12, s11, 8
    v_add_u32 v24, s12, v20
    v_and_b32 v25, 7, v24
    v_xor_b32 v25, v25, v22
    v_lshlrev_b32 v25, 5, v25
    v_lshlrev_b32 v24, 11, v24
    v_add_u32 v24, v24, v25
    v_add_u32 v24, v24, v23
    v_subrev_u32 v8, 2048, v24
    s_add_u32 s12, s11, 12
    v_add_u32 v24, s12, v20
    v_and_b32 v25, 7, v24
    v_xor_b32 v25, v25, v22
    v_lshlrev_b32 v25, 5, v25
    v_lshlrev_b32 v24, 11, v24
    v_add_u32 v24, v24, v25
    v_add_u32 v24, v24, v23
    v_subrev_u32 v9, 3072, v24
    s_lshl_b32 s20, s68, 12
    s_add_u32 s21, s20, 16384
    v_lshlrev_b32 v4, 4, v1
    v_add_u32 v5, 178176, v4
    v_lshrrev_b32 v20, 3, v1
    v_and_b32 v21, 7, v1
    v_xor_b32 v21, v21, v20
    v_lshlrev_b32 v21, 4, v21
    s_lshl_b32 s11, s6, 7
    s_lshl_b32 s12, s68, 5
    s_add_u32 s11, s11, s12
    s_add_u32 s12, s11, 0
    v_add_u32 v24, s12, v20
    v_lshlrev_b32 v24, 11, v24
    v_add_u32 v24, v24, v21
    v_subrev_u32 v10, 0, v24
    s_add_u32 s12, s11, 8
    v_add_u32 v24, s12, v20
    v_lshlrev_b32 v24, 11, v24
    v_add_u32 v24, v24, v21
    v_subrev_u32 v11, 1024, v24
    s_add_u32 s12, s11, 16
    v_add_u32 v24, s12, v20
    v_lshlrev_b32 v24, 11, v24
    v_add_u32 v24, v24, v21
    v_subrev_u32 v12, 2048, v24
    s_add_u32 s12, s11, 24
    v_add_u32 v24, s12, v20
    v_lshlrev_b32 v24, 11, v24
    v_add_u32 v24, v24, v21
    v_subrev_u32 v13, 3072, v24
    s_lshl_b32 s11, s5, 3
    s_lshl_b32 s12, s68, 1
    s_add_u32 s11, s11, s12
    s_mul_i32 s13, s11, 180224
    s_lshl_b32 s12, s7, 11
    s_add_u32 s13, s13, s12
    s_mov_b32 s9, 0
    s_waitcnt lgkmcnt(0)
    s_mov_b32 s36, s34
    s_and_b32 s37, s35, 0xffff
    s_mov_b32 s38, 23068672
    s_mov_b32 s39, 0x20000
    s_mov_b32 s44, s14
    s_and_b32 s45, s15, 0xffff
    s_mov_b32 s46, 2097152
    s_mov_b32 s47, 0x20000
    s_mov_b32 s52, s16
    s_and_b32 s53, s17, 0xffff
    s_mov_b32 s54, 2097152
    s_mov_b32 s55, 0x20000
    s_lshl_b32 s11, s5, 1
    s_lshr_b32 s12, s68, 1
    s_add_u32 s11, s11, s12
    s_lshl_b32 s11, s11, 7
    s_add_u32 s11, s11, 33554432
    v_and_b32 v14, 31, v1
    v_lshlrev_b32 v14, 2, v14
    v_add_u32 v14, s11, v14
    s_cmp_eq_u32 s68, 0
    s_cbranch_scc1 L_k1_kernel_comb
    s_barrier
    s_barrier
    s_branch L_k1_kernel_tail
L_k1_kernel_comb:
    v_and_b32 v19, 31, v1
    v_lshlrev_b32 v19, 2, v19
    v_add_u32 v20, 147456, v19
    s_barrier
    ds_read2_b32 v[32:33], v20 offset0:0 offset1:32
    ds_read2_b32 v[34:35], v20 offset0:64 offset1:96
    ds_read2_b32 v[36:37], v20 offset0:128 offset1:160
    ds_read2_b32 v[38:39], v20 offset0:192 offset1:224
    v_add_u32 v101, 1024, v20
    ds_read2_b32 v[40:41], v101 offset0:0 offset1:32
    ds_read2_b32 v[42:43], v101 offset0:64 offset1:96
    ds_read2_b32 v[44:45], v101 offset0:128 offset1:160
    ds_read2_b32 v[46:47], v101 offset0:192 offset1:224
    v_add_u32 v102, 2048, v20
    ds_read2_b32 v[48:49], v102 offset0:0 offset1:32
    ds_read2_b32 v[50:51], v102 offset0:64 offset1:96
    ds_read2_b32 v[52:53], v102 offset0:128 offset1:160
    ds_read2_b32 v[54:55], v102 offset0:192 offset1:224
    v_add_u32 v103, 3072, v20
    ds_read2_b32 v[56:57], v103 offset0:0 offset1:32
    ds_read2_b32 v[58:59], v103 offset0:64 offset1:96
    ds_read2_b32 v[60:61], v103 offset0:128 offset1:160
    ds_read2_b32 v[62:63], v103 offset0:192 offset1:224
    s_waitcnt lgkmcnt(0)
    v_fma_f32 v72, v26, v32, v34
    v_fma_f32 v73, v26, v33, v35
    v_fma_f32 v72, -v27, v33, v72
    v_fmac_f32 v73, v27, v32
    v_fma_f32 v70, v26, v72, v36
    v_fma_f32 v71, v26, v73, v37
    v_fma_f32 v70, -v27, v73, v70
    v_fmac_f32 v71, v27, v72
    v_fma_f32 v72, v26, v70, v38
    v_fma_f32 v73, v26, v71, v39
    v_fma_f32 v72, -v27, v71, v72
    v_fmac_f32 v73, v27, v70
    v_fma_f32 v70, v26, v72, v40
    v_fma_f32 v71, v26, v73, v41
    v_fma_f32 v70, -v27, v73, v70
    v_fmac_f32 v71, v27, v72
    v_fma_f32 v72, v26, v70, v42
    v_fma_f32 v73, v26, v71, v43
    v_fma_f32 v72, -v27, v71, v72
    v_fmac_f32 v73, v27, v70
    v_fma_f32 v70, v26, v72, v44
    v_fma_f32 v71, v26, v73, v45
    v_fma_f32 v70, -v27, v73, v70
    v_fmac_f32 v71, v27, v72
    v_fma_f32 v72, v26, v70, v46
    v_fma_f32 v73, v26, v71, v47
    v_fma_f32 v72, -v27, v71, v72
    v_fmac_f32 v73, v27, v70
    v_fma_f32 v70, v26, v72, v48
    v_fma_f32 v71, v26, v73, v49
    v_fma_f32 v70, -v27, v73, v70
    v_fmac_f32 v71, v27, v72
    v_fma_f32 v72, v26, v70, v50
    v_fma_f32 v73, v26, v71, v51
    v_fma_f32 v72, -v27, v71, v72
    v_fmac_f32 v73, v27, v70
    v_fma_f32 v70, v26, v72, v52
    v_fma_f32 v71, v26, v73, v53
    v_fma_f32 v70, -v27, v73, v70
    v_fmac_f32 v71, v27, v72
    v_fma_f32 v72, v26, v70, v54
    v_fma_f32 v73, v26, v71, v55
    v_fma_f32 v72, -v27, v71, v72
    v_fmac_f32 v73, v27, v70
    v_fma_f32 v70, v26, v72, v56
    v_fma_f32 v71, v26, v73, v57
    v_fma_f32 v70, -v27, v73, v70
    v_fmac_f32 v71, v27, v72
    v_fma_f32 v72, v26, v70, v58
    v_fma_f32 v73, v26, v71, v59
    v_fma_f32 v72, -v27, v71, v72
    v_fmac_f32 v73, v27, v70
    v_fma_f32 v70, v26, v72, v60
    v_fma_f32 v71, v26, v73, v61
    v_fma_f32 v70, -v27, v73, v70
    v_fmac_f32 v71, v27, v72
    v_fma_f32 v72, v26, v70, v62
    v_fma_f32 v73, v26, v71, v63
    v_fma_f32 v72, -v27, v71, v72
    v_fmac_f32 v73, v27, v70
    v_lshlrev_b32 v21, 1, v19
    s_lshl_b32 s71, s83, 8
    s_add_u32 s71, s71, 36700160
    s_mov_b32 exec_hi, 0
    buffer_store_dwordx2 v[72:73], v21, s[48:51], s71 offen sc0 sc1
    s_lshl_b32 s71, s70, 8
    s_add_u32 s71, s71, 36700160
    v_mov_b32 v70, 0
    v_mov_b32 v71, 0
    s_cmp_eq_u32 s69, 0
    s_cbranch_scc1 L_k1_kernel_cin
    s_mov_b32 s75, 30000
L_k1_kernel_gat:
    s_mov_b32 s72, s71
    buffer_load_dwordx2 v[80:81], v21, s[48:51], s72 offen sc0 sc1
    s_add_u32 s72, s72, 8192
    buffer_load_dwordx2 v[82:83], v21, s[48:51], s72 offen sc0 sc1
    s_add_u32 s72, s72, 8192
    buffer_load_dwordx2 v[84:85], v21, s[48:51], s72 offen sc0 sc1
    s_add_u32 s72, s72, 8192
    buffer_load_dwordx2 v[86:87], v21, s[48:51], s72 offen sc0 sc1
    s_add_u32 s72, s72, 8192
    buffer_load_dwordx2 v[88:89], v21, s[48:51], s72 offen sc0 sc1
    s_add_u32 s72, s72, 8192
    buffer_load_dwordx2 v[90:91], v21, s[48:51], s72 offen sc0 sc1
    s_add_u32 s72, s72, 8192
    buffer_load_dwordx2 v[92:93], v21, s[48:51], s72 offen sc0 sc1
    s_add_u32 s72, s72, 8192
    s_waitcnt vmcnt(0)
    s_mov_b64 s[86:87], 0
    v_cmp_eq_u32 vcc, -1, v80
    v_cmp_eq_u32 s[84:85], -1, v81
    s_or_b64 vcc, vcc, s[84:85]
    s_cmp_gt_u32 s69, 0
    s_cselect_b64 vcc, vcc, 0
    s_or_b64 s[86:87], s[86:87], vcc
    v_cmp_eq_u32 vcc, -1, v82
    v_cmp_eq_u32 s[84:85], -1, v83
    s_or_b64 vcc, vcc, s[84:85]
    s_cmp_gt_u32 s69, 1
    s_cselect_b64 vcc, vcc, 0
    s_or_b64 s[86:87], s[86:87], vcc
    v_cmp_eq_u32 vcc, -1, v84
    v_cmp_eq_u32 s[84:85], -1, v85
    s_or_b64 vcc, vcc, s[84:85]
    s_cmp_gt_u32 s69, 2
    s_cselect_b64 vcc, vcc, 0
    s_or_b64 s[86:87], s[86:87], vcc
    v_cmp_eq_u32 vcc, -1, v86
    v_cmp_eq_u32 s[84:85], -1, v87
    s_or_b64 vcc, vcc, s[84:85]
    s_cmp_gt_u32 s69, 3
    s_cselect_b64 vcc, vcc, 0
    s_or_b64 s[86:87], s[86:87], vcc
    v_cmp_eq_u32 vcc, -1, v88
    v_cmp_eq_u32 s[84:85], -1, v89
    s_or_b64 vcc, vcc, s[84:85]
    s_cmp_gt_u32 s69, 4
    s_cselect_b64 vcc, vcc, 0
    s_or_b64 s[86:87], s[86:87], vcc
    v_cmp_eq_u32 vcc, -1, v90
    v_cmp_eq_u32 s[84:85], -1, v91
    s_or_b64 vcc, vcc, s[84:85]
    s_cmp_gt_u32 s69, 5
    s_cselect_b64 vcc, vcc, 0
    s_or_b64 s[86:87], s[86:87], vcc
    v_cmp_eq_u32 vcc, -1, v92
    v_cmp_eq_u32 s[84:85], -1, v93
    s_or_b64 vcc, vcc, s[84:85]
    s_cmp_gt_u32 s69, 6
    s_cselect_b64 vcc, vcc, 0
    s_or_b64 s[86:87], s[86:87], vcc
    s_cmp_eq_u64 s[86:87], 0
    s_cbranch_scc1 L_k1_kernel_gok
    s_sub_u32 s75, s75, 1
    s_cmp_lg_u32 s75, 0
    s_cbranch_scc1 L_k1_kernel_gat
L_k1_kernel_gok:
    v_fma_f32 v72, v28, v70, v80
    v_fma_f32 v73, v28, v71, v81
    v_fma_f32 v72, -v29, v71, v72
    v_fmac_f32 v73, v29, v70
    v_mov_b32 v70, v72
    v_mov_b32 v71, v73
    s_cmp_eq_u32 s69, 1
    s_cbranch_scc1 L_k1_kernel_cin
    v_fma_f32 v72, v28, v70, v82
    v_fma_f32 v73, v28, v71, v83
    v_fma_f32 v72, -v29, v71, v72
    v_fmac_f32 v73, v29, v70
    v_mov_b32 v70, v72
    v_mov_b32 v71, v73
    s_cmp_eq_u32 s69, 2
    s_cbranch_scc1 L_k1_kernel_cin
    v_fma_f32 v72, v28, v70, v84
    v_fma_f32 v73, v28, v71, v85
    v_fma_f32 v72, -v29, v71, v72
    v_fmac_f32 v73, v29, v70
    v_mov_b32 v70, v72
    v_mov_b32 v71, v73
    s_cmp_eq_u32 s69, 3
    s_cbranch_scc1 L_k1_kernel_cin
    v_fma_f32 v72, v28, v70, v86
    v_fma_f32 v73, v28, v71, v87
    v_fma_f32 v72, -v29, v71, v72
    v_fmac_f32 v73, v29, v70
    v_mov_b32 v70, v72
    v_mov_b32 v71, v73
    s_cmp_eq_u32 s69, 4
    s_cbranch_scc1 L_k1_kernel_cin
    v_fma_f32 v72, v28, v70, v88
    v_fma_f32 v73, v28, v71, v89
    v_fma_f32 v72, -v29, v71, v72
    v_fmac_f32 v73, v29, v70
    v_mov_b32 v70, v72
    v_mov_b32 v71, v73
    s_cmp_eq_u32 s69, 5
    s_cbranch_scc1 L_k1_kernel_cin
    v_fma_f32 v72, v28, v70, v90
    v_fma_f32 v73, v28, v71, v91
    v_fma_f32 v72, -v29, v71, v72
    v_fmac_f32 v73, v29, v70
    v_mov_b32 v70, v72
    v_mov_b32 v71, v73
    s_cmp_eq_u32 s69, 6
    s_cbranch_scc1 L_k1_kernel_cin
    v_fma_f32 v72, v28, v70, v92
    v_fma_f32 v73, v28, v71, v93
    v_fma_f32 v72, -v29, v71, v72
    v_fmac_f32 v73, v29, v70
    v_mov_b32 v70, v72
    v_mov_b32 v71, v73
L_k1_kernel_cin:
    v_add_u32 v100, 151552, v19
    v_add_u32 v101, 152576, v19
    v_add_u32 v102, 153600, v19
    v_add_u32 v103, 154624, v19
    ds_write2_b32 v100, v70, v71 offset0:0 offset1:32
    v_fma_f32 v72, v26, v70, v32
    v_fma_f32 v73, v26, v71, v33
    v_fma_f32 v72, -v27, v71, v72
    v_fmac_f32 v73, v27, v70
    ds_write2_b32 v100, v72, v73 offset0:64 offset1:96
    v_fma_f32 v70, v26, v72, v34
    v_fma_f32 v71, v26, v73, v35
    v_fma_f32 v70, -v27, v73, v70
    v_fmac_f32 v71, v27, v72
    ds_write2_b32 v100, v70, v71 offset0:128 offset1:160
    v_fma_f32 v72, v26, v70, v36
    v_fma_f32 v73, v26, v71, v37
    v_fma_f32 v72, -v27, v71, v72
    v_fmac_f32 v73, v27, v70
    ds_write2_b32 v100, v72, v73 offset0:192 offset1:224
    v_fma_f32 v70, v26, v72, v38
    v_fma_f32 v71, v26, v73, v39
    v_fma_f32 v70, -v27, v73, v70
    v_fmac_f32 v71, v27, v72
    ds_write2_b32 v101, v70, v71 offset0:0 offset1:32
    v_fma_f32 v72, v26, v70, v40
    v_fma_f32 v73, v26, v71, v41
    v_fma_f32 v72, -v27, v71, v72
    v_fmac_f32 v73, v27, v70
    ds_write2_b32 v101, v72, v73 offset0:64 offset1:96
    v_fma_f32 v70, v26, v72, v42
    v_fma_f32 v71, v26, v73, v43
    v_fma_f32 v70, -v27, v73, v70
    v_fmac_f32 v71, v27, v72
    ds_write2_b32 v101, v70, v71 offset0:128 offset1:160
    v_fma_f32 v72, v26, v70, v44
    v_fma_f32 v73, v26, v71, v45
    v_fma_f32 v72, -v27, v71, v72
    v_fmac_f32 v73, v27, v70
    ds_write2_b32 v101, v72, v73 offset0:192 offset1:224
    v_fma_f32 v70, v26, v72, v46
    v_fma_f32 v71, v26, v73, v47
    v_fma_f32 v70, -v27, v73, v70
    v_fmac_f32 v71, v27, v72
    ds_write2_b32 v102, v70, v71 offset0:0 offset1:32
    v_fma_f32 v72, v26, v70, v48
    v_fma_f32 v73, v26, v71, v49
    v_fma_f32 v72, -v27, v71, v72
    v_fmac_f32 v73, v27, v70
    ds_write2_b32 v102, v72, v73 offset0:64 offset1:96
    v_fma_f32 v70, v26, v72, v50
    v_fma_f32 v71, v26, v73, v51
    v_fma_f32 v70, -v27, v73, v70
    v_fmac_f32 v71, v27, v72
    ds_write2_b32 v102, v70, v71 offset0:128 offset1:160
    v_fma_f32 v72, v26, v70, v52
    v_fma_f32 v73, v26, v71, v53
    v_fma_f32 v72, -v27, v71, v72
    v_fmac_f32 v73, v27, v70
    ds_write2_b32 v102, v72, v73 offset0:192 offset1:224
    v_fma_f32 v70, v26, v72, v54
    v_fma_f32 v71, v26, v73, v55
    v_fma_f32 v70, -v27, v73, v70
    v_fmac_f32 v71, v27, v72
    ds_write2_b32 v103, v70, v71 offset0:0 offset1:32
    v_fma_f32 v72, v26, v70, v56
    v_fma_f32 v73, v26, v71, v57
    v_fma_f32 v72, -v27, v71, v72
    v_fmac_f32 v73, v27, v70
    ds_write2_b32 v103, v72, v73 offset0:64 offset1:96
    v_fma_f32 v70, v26, v72, v58
    v_fma_f32 v71, v26, v73, v59
    v_fma_f32 v70, -v27, v73, v70
    v_fmac_f32 v71, v27, v72
    ds_write2_b32 v103, v70, v71 offset0:128 offset1:160
    v_fma_f32 v72, v26, v70, v60
    v_fma_f32 v73, v26, v71, v61
    v_fma_f32 v72, -v27, v71, v72
    v_fmac_f32 v73, v27, v70
    ds_write2_b32 v103, v72, v73 offset0:192 offset1:224
    s_waitcnt lgkmcnt(0)
    s_barrier
    s_mov_b64 exec, -1
L_k1_kernel_tail:
    s_mov_b32 s40, s24
    s_and_b32 s41, s25, 0xffff
    s_mov_b32 s42, 7340032
    s_mov_b32 s43, 0x20000
    s_lshl_b32 s18, s7, 17
    s_lshl_b32 s12, s6, 8
    s_add_u32 s18, s18, s12
    s_add_u32 m0, s21, 0
    s_nop 0
    buffer_load_dwordx4 v6, s[40:43], s18 offen offset:0 lds
    buffer_load_dwordx4 v7, s[40:43], s18 offen offset:1024 lds
    buffer_load_dwordx4 v8, s[40:43], s18 offen offset:2048 lds
    buffer_load_dwordx4 v9, s[40:43], s18 offen offset:3072 lds
    s_add_u32 s18, s18, 131072
    s_add_u32 m0, s21, 32768
    s_nop 0
    buffer_load_dwordx4 v6, s[40:43], s18 offen offset:0 lds
    buffer_load_dwordx4 v7, s[40:43], s18 offen offset:1024 lds
    buffer_load_dwordx4 v8, s[40:43], s18 offen offset:2048 lds
    buffer_load_dwordx4 v9, s[40:43], s18 offen offset:3072 lds
    s_add_u32 s18, s18, 131072
    s_add_u32 m0, s21, 65536
    s_nop 0
    buffer_load_dwordx4 v6, s[40:43], s18 offen offset:0 lds
    buffer_load_dwordx4 v7, s[40:43], s18 offen offset:1024 lds
    buffer_load_dwordx4 v8, s[40:43], s18 offen offset:2048 lds
    buffer_load_dwordx4 v9, s[40:43], s18 offen offset:3072 lds
    s_add_u32 s18, s18, 131072
    s_mov_b32 s22, 40000
    s_mov_b32 s11, 0
    s_lshl_b32 s12, s4, 4
    s_lshl_b32 s23, 0xffff, s12
L_k2l_pl1:
    buffer_load_dword v15, v14, s[48:51], s11 offen sc0 sc1
    s_waitcnt vmcnt(0)
    v_cmp_ne_u32 vcc, 1, v15
    s_and_b32 s12, vcc_lo, s23
    s_cbranch_scc0 L_k2l_po1
    s_sleep 2
    s_sub_u32 s22, s22, 1
    s_cmp_lg_u32 s22, 0
    s_cbranch_scc1 L_k2l_pl1
L_k2l_po1:
    s_mov_b32 m0, s20
    s_nop 0
    buffer_load_dwordx4 v4, s[36:39], s13 offen lds
    buffer_load_dwordx4 v4, s[36:39], s13 offen offset:1024 lds
    buffer_load_dwordx4 v5, s[36:39], s13 offen offset:2048 lds
    buffer_load_dwordx4 v5, s[36:39], s13 offen offset:3072 lds
    s_add_u32 s13, s13, 2048
    s_add_u32 s9, s9, 32768
    s_cmp_eq_u32 s9, 163840
    s_cselect_b32 s9, 0, s9
    s_add_u32 m0, s9, s20
    s_add_u32 s19, s9, s21
    s_nop 0
    buffer_load_dwordx4 v4, s[36:39], s13 offen lds
    buffer_load_dwordx4 v4, s[36:39], s13 offen offset:1024 lds
    buffer_load_dwordx4 v5, s[36:39], s13 offen offset:2048 lds
    buffer_load_dwordx4 v5, s[36:39], s13 offen offset:3072 lds
    s_add_u32 s13, s13, 2048
    s_add_u32 s9, s9, 32768
    s_cmp_eq_u32 s9, 163840
    s_cselect_b32 s9, 0, s9
    s_add_u32 m0, s9, s20
    s_add_u32 s19, s9, s21
    s_nop 0
    buffer_load_dwordx4 v4, s[36:39], s13 offen lds
    buffer_load_dwordx4 v4, s[36:39], s13 offen offset:1024 lds
    buffer_load_dwordx4 v5, s[36:39], s13 offen offset:2048 lds
    buffer_load_dwordx4 v5, s[36:39], s13 offen offset:3072 lds
    s_add_u32 s13, s13, 2048
    s_add_u32 s9, s9, 32768
    s_cmp_eq_u32 s9, 163840
    s_cselect_b32 s9, 0, s9
    s_add_u32 m0, s9, s20
    s_add_u32 s19, s9, s21
    s_nop 0
    s_waitcnt vmcnt(8)
    s_barrier
    buffer_load_dwordx4 v4, s[36:39], s13 offen lds
    buffer_load_dwordx4 v4, s[36:39], s13 offen offset:1024 lds
    buffer_load_dwordx4 v5, s[36:39], s13 offen offset:2048 lds
    buffer_load_dwordx4 v5, s[36:39], s13 offen offset:3072 lds
    s_mov_b32 m0, s19
    s_nop 0
    buffer_load_dwordx4 v6, s[40:43], s18 offen offset:0 lds
    buffer_load_dwordx4 v7, s[40:43], s18 offen offset:1024 lds
    buffer_load_dwordx4 v8, s[40:43], s18 offen offset:2048 lds
    buffer_load_dwordx4 v9, s[40:43], s18 offen offset:3072 lds
    s_add_u32 s18, s18, 131072
    s_add_u32 s13, s13, 2048
    s_add_u32 s9, s9, 32768
    s_cmp_eq_u32 s9, 163840
    s_cselect_b32 s9, 0, s9
    s_add_u32 m0, s9, s20
    s_add_u32 s19, s9, s21
    s_waitcnt vmcnt(12)
    s_barrier
    s_mov_b32 s8, 22
L_k2l_lH:
    buffer_load_dwordx4 v4, s[36:39], s13 offen lds
    buffer_load_dwordx4 v4, s[36:39], s13 offen offset:1024 lds
    buffer_load_dwordx4 v5, s[36:39], s13 offen offset:2048 lds
    buffer_load_dwordx4 v5, s[36:39], s13 offen offset:3072 lds
    s_mov_b32 m0, s19
    s_nop 0
    buffer_load_dwordx4 v6, s[40:43], s18 offen offset:0 lds
    buffer_load_dwordx4 v7, s[40:43], s18 offen offset:1024 lds
    buffer_load_dwordx4 v8, s[40:43], s18 offen offset:2048 lds
    buffer_load_dwordx4 v9, s[40:43], s18 offen offset:3072 lds
    s_add_u32 s18, s18, 131072
    s_add_u32 s13, s13, 2048
    s_add_u32 s9, s9, 32768
    s_cmp_eq_u32 s9, 163840
    s_cselect_b32 s9, 0, s9
    s_add_u32 m0, s9, s20
    s_add_u32 s19, s9, s21
    s_sub_u32 s8, s8, 1
    s_cmp_lg_u32 s8, 0
    s_waitcnt vmcnt(16)
    s_barrier
    s_cbranch_scc1 L_k2l_lH
    v_lshrrev_b32 v16, 5, v1
    v_xor_b32 v16, 1, v16
    v_lshlrev_b32 v16, 12, v16
    v_add_u32 v16, v16, v14
    buffer_load_dword v15, v16, s[48:51], 0 offen sc0 sc1
    buffer_load_dwordx4 v4, s[36:39], s13 offen lds
    buffer_load_dwordx4 v4, s[36:39], s13 offen offset:1024 lds
    buffer_load_dwordx4 v5, s[36:39], s13 offen offset:2048 lds
    buffer_load_dwordx4 v5, s[36:39], s13 offen offset:3072 lds
    s_mov_b32 m0, s19
    s_nop 0
    buffer_load_dwordx4 v6, s[40:43], s18 offen offset:0 lds
    buffer_load_dwordx4 v7, s[40:43], s18 offen offset:1024 lds
    buffer_load_dwordx4 v8, s[40:43], s18 offen offset:2048 lds
    buffer_load_dwordx4 v9, s[40:43], s18 offen offset:3072 lds
    s_add_u32 s18, s18, 131072
    s_add_u32 s13, s13, 2048
    s_add_u32 s9, s9, 32768
    s_cmp_eq_u32 s9, 163840
    s_cselect_b32 s9, 0, s9
    s_add_u32 m0, s9, s20
    s_add_u32 s19, s9, s21
    s_waitcnt vmcnt(17)
    s_barrier
    buffer_load_dwordx4 v4, s[36:39], s13 offen lds
    buffer_load_dwordx4 v4, s[36:39], s13 offen offset:1024 lds
    buffer_load_dwordx4 v5, s[36:39], s13 offen offset:2048 lds
    buffer_load_dwordx4 v5, s[36:39], s13 offen offset:3072 lds
    s_mov_b32 m0, s19
    s_nop 0
    buffer_load_dwordx4 v6, s[40:43], s18 offen offset:0 lds
    buffer_load_dwordx4 v7, s[40:43], s18 offen offset:1024 lds
    buffer_load_dwordx4 v8, s[40:43], s18 offen offset:2048 lds
    buffer_load_dwordx4 v9, s[40:43], s18 offen offset:3072 lds
    s_add_u32 s18, s18, 131072
    s_add_u32 s13, s13, 2048
    s_add_u32 s9, s9, 32768
    s_cmp_eq_u32 s9, 163840
    s_cselect_b32 s9, 0, s9
    s_add_u32 m0, s9, s20
    s_add_u32 s19, s9, s21
    s_waitcnt vmcnt(16)
    s_barrier
    s_lshl_b32 s12, s4, 4
    s_lshl_b32 s23, 0xffff, s12
    s_mov_b32 s22, 40000
    v_cmp_ne_u32 vcc, 1, v15
    s_and_b32 s12, vcc_lo, s23
    s_or_b32 s12, s12, vcc_hi
    s_cbranch_scc0 L_k2l_poh
L_k2l_plh:
    buffer_load_dword v15, v16, s[48:51], 0 offen sc0 sc1
    s_waitcnt vmcnt(0)
    v_cmp_ne_u32 vcc, 1, v15
    s_and_b32 s12, vcc_lo, s23
    s_or_b32 s12, s12, vcc_hi
    s_cbranch_scc0 L_k2l_poh
    s_sleep 2
    s_sub_u32 s22, s22, 1
    s_cmp_lg_u32 s22, 0
    s_cbranch_scc1 L_k2l_plh
L_k2l_poh:
    s_mul_i32 s12, s4, 24576
    s_sub_u32 s12, 57344, s12
    s_add_u32 s13, s13, s12
    s_lshl_b32 s18, s4, 10
    s_mov_b32 s8, 8
L_k2l_lh:
    buffer_load_dwordx4 v4, s[36:39], s13 offen lds
    buffer_load_dwordx4 v4, s[36:39], s13 offen offset:1024 lds
    buffer_load_dwordx4 v5, s[36:39], s13 offen offset:2048 lds
    buffer_load_dwordx4 v5, s[36:39], s13 offen offset:3072 lds
    s_mov_b32 m0, s19
    s_nop 0
    buffer_load_dwordx4 v10, s[44:47], s18 offen offset:0 lds
    buffer_load_dwordx4 v11, s[44:47], s18 offen offset:1024 lds
    buffer_load_dwordx4 v12, s[44:47], s18 offen offset:2048 lds
    buffer_load_dwordx4 v13, s[44:47], s18 offen offset:3072 lds
    s_add_u32 s13, s13, 2048
    s_add_u32 s9, s9, 32768
    s_cmp_eq_u32 s9, 163840
    s_cselect_b32 s9, 0, s9
    s_add_u32 m0, s9, s20
    s_add_u32 s19, s9, s21
    s_waitcnt vmcnt(16)
    s_barrier
    buffer_load_dwordx4 v4, s[36:39], s13 offen lds
    buffer_load_dwordx4 v4, s[36:39], s13 offen offset:1024 lds
    buffer_load_dwordx4 v5, s[36:39], s13 offen offset:2048 lds
    buffer_load_dwordx4 v5, s[36:39], s13 offen offset:3072 lds
    s_mov_b32 m0, s19
    s_nop 0
    buffer_load_dwordx4 v10, s[52:55], s18 offen offset:0 lds
    buffer_load_dwordx4 v11, s[52:55], s18 offen offset:1024 lds
    buffer_load_dwordx4 v12, s[52:55], s18 offen offset:2048 lds
    buffer_load_dwordx4 v13, s[52:55], s18 offen offset:3072 lds
    s_add_u32 s18, s18, 128
    s_add_u32 s13, s13, 2048
    s_add_u32 s9, s9, 32768
    s_cmp_eq_u32 s9, 163840
    s_cselect_b32 s9, 0, s9
    s_add_u32 m0, s9, s20
    s_add_u32 s19, s9, s21
    s_sub_u32 s8, s8, 1
    s_cmp_lg_u32 s8, 0
    s_waitcnt vmcnt(16)
    s_barrier
    s_cbranch_scc1 L_k2l_lh
L_k2l_ltail:
    s_mov_b32 s56, s28
    s_and_b32 s57, s29, 0xffff
    s_mov_b32 s58, 4194304
    s_mov_b32 s59, 0x20000
    s_mov_b32 s60, s30
    s_and_b32 s61, s31, 0xffff
    s_mov_b32 s62, 2048
    s_mov_b32 s63, 0x20000
    s_mov_b32 s64, s26
    s_and_b32 s65, s27, 0xffff
    s_mov_b32 s66, 2048
    s_mov_b32 s67, 0x20000
    s_lshl_b32 s11, s5, 7
    s_lshr_b32 s12, s68, 1
    s_lshl_b32 s12, s12, 6
    s_add_u32 s11, s11, s12
    s_lshl_b32 s12, s4, 3
    s_add_u32 s11, s11, s12
    s_and_b32 s12, s68, 1
    s_lshl_b32 s12, s12, 2
    s_add_u32 s11, s11, s12
    s_lshl_b32 s10, s6, 8
    s_lshl_b32 s13, s11, 11
    s_add_u32 s13, s13, s10
    s_lshl_b32 s18, s11, 4
    s_add_u32 s18, s18, 34603008
    v_lshrrev_b32 v20, 4, v1
    v_and_b32 v21, 15, v1
    v_lshlrev_b32 v22, 11, v20
    s_add_u32 m0, s20, 131072
    v_add_u32 v23, 0, v20
    v_xor_b32 v23, v23, v21
    v_lshlrev_b32 v23, 4, v23
    v_add_u32 v23, v23, v22
    v_add_u32 v24, 0, v23
    v_add_u32 v23, 4, v20
    v_xor_b32 v23, v23, v21
    v_lshlrev_b32 v23, 4, v23
    v_add_u32 v23, v23, v22
    v_add_u32 v25, 31744, v23
    v_add_u32 v23, 8, v20
    v_xor_b32 v23, v23, v21
    v_lshlrev_b32 v23, 4, v23
    v_add_u32 v23, v23, v22
    v_add_u32 v26, 63488, v23
    v_add_u32 v23, 12, v20
    v_xor_b32 v23, v23, v21
    v_lshlrev_b32 v23, 4, v23
    v_add_u32 v23, v23, v22
    v_add_u32 v27, 95232, v23
    buffer_load_dwordx4 v24, s[56:59], s13 offen offset:0 lds
    buffer_load_dwordx4 v25, s[56:59], s13 offen offset:1024 lds
    buffer_load_dwordx4 v26, s[56:59], s13 offen offset:2048 lds
    buffer_load_dwordx4 v27, s[56:59], s13 offen offset:3072 lds
    v_lshrrev_b32 v20, 2, v21
    v_lshlrev_b32 v20, 4, v20
    v_and_b32 v22, 3, v21
    v_add_u32 v20, v20, v22
    v_lshlrev_b32 v20, 4, v20
    v_lshlrev_b32 v21, 4, v21
    s_lshl_b32 s12, s68, 8
    s_add_u32 m0, s12, 147456
    s_mov_b64 exec, 0xffff
    buffer_load_dwordx4 v20, s[48:51], s18 offen sc0 sc1 lds
    s_mov_b32 m0, 148480
    s_nop 0
    buffer_load_dwordx4 v21, s[60:63], s10 offen lds
    s_mov_b32 m0, 148736
    s_nop 0
    buffer_load_dwordx4 v21, s[64:67], s10 offen lds
    s_mov_b64 exec, -1
    s_waitcnt vmcnt(15)
    s_barrier
    s_waitcnt vmcnt(7)
    s_barrier
    s_waitcnt vmcnt(0)
    s_barrier
L_k1_kernel_end:
    s_endpgm
L_k2c_entry:
    s_load_dwordx2 s[4:5], s[0:1], 0
    s_load_dwordx4 s[8:11], s[0:1], 40
    s_load_dwordx2 s[6:7], s[0:1], 64
    s_load_dwordx4 s[12:15], s[0:1], 96
    s_load_dwordx2 s[16:17], s[0:1], 120
    s_load_dwordx2 s[18:19], s[0:1], 136
    v_and_b32 v1, 63, v0
    v_lshrrev_b32 v2, 6, v0
    s_nop 0
    v_readfirstlane_b32 s60, v2
    s_and_b32 s68, s2, 7
    s_lshr_b32 s69, s2, 3
    s_and_b32 s61, s68, 1
    s_lshr_b32 s68, s68, 1
    s_lshl_b32 s68, s68, 2
    s_and_b32 s70, s69, 3
    s_add_u32 s62, s68, s70
    s_lshr_b32 s63, s69, 2
    s_mul_i32 s64, s61, 44
    s_lshl_b32 s76, s62, 3
    s_add_u32 s76, s76, s63
    s_and_b32 s68, s60, 1
    s_lshr_b32 s69, s60, 1
    v_and_b32 v2, 15, v1
    v_lshrrev_b32 v3, 4, v1
    s_lshl_b32 s70, s68, 13
    v_lshlrev_b32 v4, 4, v1
    v_add_u32 v4, s70, v4
    v_lshrrev_b32 v26, 2, v1
    v_and_b32 v27, 7, v26
    v_and_b32 v28, 3, v1
    v_lshlrev_b32 v28, 3, v28
    v_lshlrev_b32 v29, 8, v26
    v_add_u32 v29, v29, v28
    v_add_u32 v29, 0x4000, v29
    s_lshl_b32 s70, s69, 2
    s_add_u32 s65, s70, 0
    v_xor_b32 v30, s65, v27
    v_lshlrev_b32 v30, 5, v30
    v_add_u32 v5, v29, v30
    s_add_u32 s65, s70, 1
    v_xor_b32 v30, s65, v27
    v_lshlrev_b32 v30, 5, v30
    v_add_u32 v6, v29, v30
    s_add_u32 s65, s70, 2
    v_xor_b32 v30, s65, v27
    v_lshlrev_b32 v30, 5, v30
    v_add_u32 v7, v29, v30
    s_add_u32 s65, s70, 3
    v_xor_b32 v30, s65, v27
    v_lshlrev_b32 v30, 5, v30
    v_add_u32 v8, v29, v30
    s_lshl_b32 s70, s69, 6
    v_add_u32 v30, s70, v2
    v_lshlrev_b32 v30, 7, v30
    v_add_u32 v30, 0x4000, v30
    v_and_b32 v31, 7, v2
    v_add_u32 v32, 0, v3
    v_xor_b32 v32, v32, v31
    v_lshlrev_b32 v32, 4, v32
    v_add_u32 v9, v30, v32
    v_add_u32 v32, 4, v3
    v_xor_b32 v32, v32, v31
    v_lshlrev_b32 v32, 4, v32
    v_add_u32 v10, v30, v32
    s_lshl_b32 s70, s62, 7
    s_lshl_b32 s65, s68, 6
    s_add_u32 s70, s70, s65
    s_lshl_b32 s65, s61, 3
    s_add_u32 s70, s70, s65
    v_lshrrev_b32 v33, 2, v2
    v_lshlrev_b32 v33, 4, v33
    v_and_b32 v34, 3, v2
    v_add_u32 v33, v33, v34
    v_add_u32 v33, s70, v33
    s_lshl_b32 s70, s63, 7
    s_lshl_b32 s65, s69, 6
    s_add_u32 s70, s70, s65
    v_lshlrev_b32 v34, 2, v3
    v_add_u32 v34, s70, v34
    v_lshlrev_b32 v35, 11, v33
    v_lshlrev_b32 v36, 1, v34
    v_add_u32 v226, v35, v36
    v_lshlrev_b32 v227, 1, v226
    v_lshlrev_b32 v37, 4, v33
    v_mov_b32 v228, v36
    v_add_u32 v229, 1048576, v37
    v_mov_b32 v231, 0
    v_mov_b32 v232, 1
    s_lshl_b32 s70, s68, 5
    v_add_u32 v38, s70, v2
    v_lshlrev_b32 v39, 8, v38
    v_and_b32 v40, 1, v3
    v_lshlrev_b32 v40, 3, v40
    v_add_u32 v39, v39, v40
    v_add_u32 v39, 131072, v39
    s_lshl_b32 s70, s69, 3
    v_lshrrev_b32 v40, 1, v3
    v_add_u32 v40, s70, v40
    v_add_u32 v41, 0, v40
    v_xor_b32 v41, v41, v2
    v_lshlrev_b32 v41, 4, v41
    v_add_u32 v233, v39, v41
    v_add_u32 v41, 2, v40
    v_xor_b32 v41, v41, v2
    v_lshlrev_b32 v41, 4, v41
    v_add_u32 v234, v39, v41
    v_add_u32 v41, 4, v40
    v_xor_b32 v41, v41, v2
    v_lshlrev_b32 v41, 4, v41
    v_add_u32 v235, v39, v41
    v_add_u32 v41, 6, v40
    v_xor_b32 v41, v41, v2
    v_lshlrev_b32 v41, 4, v41
    v_add_u32 v236, v39, v41
    v_lshlrev_b32 v237, 4, v38
    v_add_u32 v237, 147468, v237
    s_lshl_b32 s70, s69, 7
    v_lshlrev_b32 v238, 3, v3
    v_add_u32 v238, s70, v238
    v_add_u32 v238, 148480, v238
    v_mov_b32 v128, 0
    v_mov_b32 v129, 0
    v_mov_b32 v130, 0
    v_mov_b32 v131, 0
    v_mov_b32 v132, 0
    v_mov_b32 v133, 0
    v_mov_b32 v134, 0
    v_mov_b32 v135, 0
    v_mov_b32 v136, 0
    v_mov_b32 v137, 0
    v_mov_b32 v138, 0
    v_mov_b32 v139, 0
    v_mov_b32 v140, 0
    v_mov_b32 v141, 0
    v_mov_b32 v142, 0
    v_mov_b32 v143, 0
    v_mov_b32 v144, 0
    v_mov_b32 v145, 0
    v_mov_b32 v146, 0
    v_mov_b32 v147, 0
    v_mov_b32 v148, 0
    v_mov_b32 v149, 0
    v_mov_b32 v150, 0
    v_mov_b32 v151, 0
    v_mov_b32 v152, 0
    v_mov_b32 v153, 0
    v_mov_b32 v154, 0
    v_mov_b32 v155, 0
    v_mov_b32 v156, 0
    v_mov_b32 v157, 0
    v_mov_b32 v158, 0
    v_mov_b32 v159, 0
    v_mov_b32 v160, 0
    v_mov_b32 v161, 0
    v_mov_b32 v162, 0
    v_mov_b32 v163, 0
    v_mov_b32 v164, 0
    v_mov_b32 v165, 0
    v_mov_b32 v166, 0
    v_mov_b32 v167, 0
    v_mov_b32 v168, 0
    v_mov_b32 v169, 0
    v_mov_b32 v170, 0
    v_mov_b32 v171, 0
    v_mov_b32 v172, 0
    v_mov_b32 v173, 0
    v_mov_b32 v174, 0
    v_mov_b32 v175, 0
    v_mov_b32 v176, 0
    v_mov_b32 v177, 0
    v_mov_b32 v178, 0
    v_mov_b32 v179, 0
    v_mov_b32 v180, 0
    v_mov_b32 v181, 0
    v_mov_b32 v182, 0
    v_mov_b32 v183, 0
    v_mov_b32 v184, 0
    v_mov_b32 v185, 0
    v_mov_b32 v186, 0
    v_mov_b32 v187, 0
    v_mov_b32 v188, 0
    v_mov_b32 v189, 0
    v_mov_b32 v190, 0
    v_mov_b32 v191, 0
    s_mov_b32 s66, 0
    s_waitcnt lgkmcnt(0)
    s_mov_b32 s40, s16
    s_and_b32 s41, s17, 0xffff
    s_mov_b32 s42, 8388608
    s_mov_b32 s43, 0x20000
    s_add_u32 s44, s18, 37748736
    s_addc_u32 s45, s19, 0
    s_and_b32 s45, s45, 0xffff
    s_mov_b32 s46, 4194304
    s_mov_b32 s47, 0x20000
    s_add_u32 s48, s18, 33554432
    s_addc_u32 s49, s19, 0
    s_and_b32 s49, s49, 0xffff
    s_mov_b32 s50, 2097152
    s_mov_b32 s51, 0x20000
    v_add_u32 v11, s66, v4
    v_add_u32 v12, s66, v5
    v_add_u32 v13, s66, v6
    v_add_u32 v14, s66, v7
    v_add_u32 v15, s66, v8
    s_barrier
    ds_read_b128 v[64:67], v11 offset:0
    ds_read_b64_tr_b16 v[80:81], v12 offset:0
    ds_read_b64_tr_b16 v[82:83], v12 offset:4096
    ds_read_b128 v[68:71], v11 offset:2048
    ds_read_b128 v[72:75], v11 offset:4096
    ds_read_b128 v[76:79], v11 offset:6144
    ds_read_b64_tr_b16 v[84:85], v13 offset:0
    ds_read_b64_tr_b16 v[86:87], v13 offset:4096
    ds_read_b64_tr_b16 v[88:89], v14 offset:0
    ds_read_b64_tr_b16 v[90:91], v14 offset:4096
    ds_read_b64_tr_b16 v[92:93], v15 offset:0
    ds_read_b64_tr_b16 v[94:95], v15 offset:4096
    s_barrier
    s_mov_b32 s65, 27
L_k2_kernel_hh:
    s_waitcnt lgkmcnt(9)
    v_mfma_f32_16x16x32_bf16 v[128:131], v[80:83], v[64:67], v[128:131]
    ds_read_b128 v[96:99], v11 offset:1024
    s_waitcnt lgkmcnt(9)
    v_mfma_f32_16x16x32_bf16 v[144:147], v[80:83], v[68:71], v[144:147]
    ds_read_b64_tr_b16 v[112:113], v12 offset:8192
    s_waitcnt lgkmcnt(9)
    v_mfma_f32_16x16x32_bf16 v[160:163], v[80:83], v[72:75], v[160:163]
    ds_read_b64_tr_b16 v[114:115], v12 offset:12288
    s_waitcnt lgkmcnt(9)
    v_mfma_f32_16x16x32_bf16 v[176:179], v[80:83], v[76:79], v[176:179]
    ds_read_b128 v[100:103], v11 offset:3072
    s_waitcnt lgkmcnt(8)
    v_mfma_f32_16x16x32_bf16 v[132:135], v[84:87], v[64:67], v[132:135]
    ds_read_b128 v[104:107], v11 offset:5120
    v_mfma_f32_16x16x32_bf16 v[148:151], v[84:87], v[68:71], v[148:151]
    ds_read_b128 v[108:111], v11 offset:7168
    v_mfma_f32_16x16x32_bf16 v[164:167], v[84:87], v[72:75], v[164:167]
    ds_read_b64_tr_b16 v[116:117], v13 offset:8192
    v_mfma_f32_16x16x32_bf16 v[180:183], v[84:87], v[76:79], v[180:183]
    ds_read_b64_tr_b16 v[118:119], v13 offset:12288
    s_waitcnt lgkmcnt(10)
    v_mfma_f32_16x16x32_bf16 v[136:139], v[88:91], v[64:67], v[136:139]
    ds_read_b64_tr_b16 v[120:121], v14 offset:8192
    v_mfma_f32_16x16x32_bf16 v[152:155], v[88:91], v[68:71], v[152:155]
    ds_read_b64_tr_b16 v[122:123], v14 offset:12288
    v_mfma_f32_16x16x32_bf16 v[168:171], v[88:91], v[72:75], v[168:171]
    ds_read_b64_tr_b16 v[124:125], v15 offset:8192
    v_mfma_f32_16x16x32_bf16 v[184:187], v[88:91], v[76:79], v[184:187]
    ds_read_b64_tr_b16 v[126:127], v15 offset:12288
    s_waitcnt lgkmcnt(12)
    v_mfma_f32_16x16x32_bf16 v[140:143], v[92:95], v[64:67], v[140:143]
    s_add_u32 s67, s66, 32768
    s_cmp_eq_u32 s67, 163840
    v_mfma_f32_16x16x32_bf16 v[156:159], v[92:95], v[68:71], v[156:159]
    s_cselect_b32 s67, 0, s67
    v_add_u32 v18, s67, v4
    v_mfma_f32_16x16x32_bf16 v[172:175], v[92:95], v[72:75], v[172:175]
    v_add_u32 v19, s67, v5
    v_add_u32 v20, s67, v6
    v_mfma_f32_16x16x32_bf16 v[188:191], v[92:95], v[76:79], v[188:191]
    v_add_u32 v21, s67, v7
    v_add_u32 v22, s67, v8
    s_waitcnt lgkmcnt(9)
    v_mfma_f32_16x16x32_bf16 v[128:131], v[112:115], v[96:99], v[128:131]
    ds_read_b128 v[64:67], v18 offset:0
    s_waitcnt lgkmcnt(9)
    v_mfma_f32_16x16x32_bf16 v[144:147], v[112:115], v[100:103], v[144:147]
    ds_read_b64_tr_b16 v[80:81], v19 offset:0
    s_waitcnt lgkmcnt(9)
    v_mfma_f32_16x16x32_bf16 v[160:163], v[112:115], v[104:107], v[160:163]
    ds_read_b64_tr_b16 v[82:83], v19 offset:4096
    s_waitcnt lgkmcnt(9)
    v_mfma_f32_16x16x32_bf16 v[176:179], v[112:115], v[108:111], v[176:179]
    ds_read_b128 v[68:71], v18 offset:2048
    s_waitcnt lgkmcnt(8)
    v_mfma_f32_16x16x32_bf16 v[132:135], v[116:119], v[96:99], v[132:135]
    ds_read_b128 v[72:75], v18 offset:4096
    v_mfma_f32_16x16x32_bf16 v[148:151], v[116:119], v[100:103], v[148:151]
    ds_read_b128 v[76:79], v18 offset:6144
    v_mfma_f32_16x16x32_bf16 v[164:167], v[116:119], v[104:107], v[164:167]
    ds_read_b64_tr_b16 v[84:85], v20 offset:0
    v_mfma_f32_16x16x32_bf16 v[180:183], v[116:119], v[108:111], v[180:183]
    ds_read_b64_tr_b16 v[86:87], v20 offset:4096
    s_waitcnt lgkmcnt(10)
    v_mfma_f32_16x16x32_bf16 v[136:139], v[120:123], v[96:99], v[136:139]
    ds_read_b64_tr_b16 v[88:89], v21 offset:0
    v_mfma_f32_16x16x32_bf16 v[152:155], v[120:123], v[100:103], v[152:155]
    ds_read_b64_tr_b16 v[90:91], v21 offset:4096
    v_mfma_f32_16x16x32_bf16 v[168:171], v[120:123], v[104:107], v[168:171]
    ds_read_b64_tr_b16 v[92:93], v22 offset:0
    v_mfma_f32_16x16x32_bf16 v[184:187], v[120:123], v[108:111], v[184:187]
    ds_read_b64_tr_b16 v[94:95], v22 offset:4096
    s_waitcnt lgkmcnt(12)
    v_mfma_f32_16x16x32_bf16 v[140:143], v[124:127], v[96:99], v[140:143]
    s_mov_b32 s66, s67
    v_mov_b32 v11, v18
    v_mfma_f32_16x16x32_bf16 v[156:159], v[124:127], v[100:103], v[156:159]
    v_mov_b32 v12, v19
    v_mov_b32 v13, v20
    v_mfma_f32_16x16x32_bf16 v[172:175], v[124:127], v[104:107], v[172:175]
    v_mov_b32 v14, v21
    v_mov_b32 v15, v22
    v_mfma_f32_16x16x32_bf16 v[188:191], v[124:127], v[108:111], v[188:191]
    s_barrier
    s_cmp_lg_u32 s65, 25
    s_cbranch_scc1 L_k2_kernel_nohf
    s_waitcnt vmcnt(0)
    s_mov_b64 exec, 1
    buffer_store_dword v232, v231, s[48:51], s77 offen sc0 sc1
    s_mov_b64 exec, -1
L_k2_kernel_nohf:
    s_sub_u32 s65, s65, 1
    s_cmp_lg_u32 s65, 0
    s_cbranch_scc1 L_k2_kernel_hh
L_k2_kernel_r1:
    s_waitcnt lgkmcnt(9)
    v_mfma_f32_16x16x32_bf16 v[128:131], v[80:83], v[64:67], v[128:131]
    ds_read_b128 v[96:99], v11 offset:1024
    s_waitcnt lgkmcnt(9)
    v_mfma_f32_16x16x32_bf16 v[144:147], v[80:83], v[68:71], v[144:147]
    ds_read_b64_tr_b16 v[112:113], v12 offset:8192
    s_waitcnt lgkmcnt(9)
    v_mfma_f32_16x16x32_bf16 v[160:163], v[80:83], v[72:75], v[160:163]
    ds_read_b64_tr_b16 v[114:115], v12 offset:12288
    s_waitcnt lgkmcnt(9)
    v_mfma_f32_16x16x32_bf16 v[176:179], v[80:83], v[76:79], v[176:179]
    ds_read_b128 v[100:103], v11 offset:3072
    s_waitcnt lgkmcnt(8)
    v_mfma_f32_16x16x32_bf16 v[132:135], v[84:87], v[64:67], v[132:135]
    ds_read_b128 v[104:107], v11 offset:5120
    v_mfma_f32_16x16x32_bf16 v[148:151], v[84:87], v[68:71], v[148:151]
    ds_read_b128 v[108:111], v11 offset:7168
    v_mfma_f32_16x16x32_bf16 v[164:167], v[84:87], v[72:75], v[164:167]
    ds_read_b64_tr_b16 v[116:117], v13 offset:8192
    v_mfma_f32_16x16x32_bf16 v[180:183], v[84:87], v[76:79], v[180:183]
    ds_read_b64_tr_b16 v[118:119], v13 offset:12288
    s_waitcnt lgkmcnt(10)
    v_mfma_f32_16x16x32_bf16 v[136:139], v[88:91], v[64:67], v[136:139]
    ds_read_b64_tr_b16 v[120:121], v14 offset:8192
    v_mfma_f32_16x16x32_bf16 v[152:155], v[88:91], v[68:71], v[152:155]
    ds_read_b64_tr_b16 v[122:123], v14 offset:12288
    v_mfma_f32_16x16x32_bf16 v[168:171], v[88:91], v[72:75], v[168:171]
    ds_read_b64_tr_b16 v[124:125], v15 offset:8192
    v_mfma_f32_16x16x32_bf16 v[184:187], v[88:91], v[76:79], v[184:187]
    ds_read_b64_tr_b16 v[126:127], v15 offset:12288
    s_waitcnt lgkmcnt(12)
    v_mfma_f32_16x16x32_bf16 v[140:143], v[92:95], v[64:67], v[140:143]
    s_add_u32 s67, s66, 32768
    s_cmp_eq_u32 s67, 163840
    v_mfma_f32_16x16x32_bf16 v[156:159], v[92:95], v[68:71], v[156:159]
    s_cselect_b32 s67, 0, s67
    v_add_u32 v18, s67, v4
    v_mfma_f32_16x16x32_bf16 v[172:175], v[92:95], v[72:75], v[172:175]
    v_add_u32 v23, s67, v9
    v_add_u32 v24, s67, v10
    v_mfma_f32_16x16x32_bf16 v[188:191], v[92:95], v[76:79], v[188:191]
    s_waitcnt lgkmcnt(9)
    v_mfma_f32_16x16x32_bf16 v[128:131], v[112:115], v[96:99], v[128:131]
    ds_read_b128 v[64:67], v18 offset:0
    s_waitcnt lgkmcnt(9)
    v_mfma_f32_16x16x32_bf16 v[144:147], v[112:115], v[100:103], v[144:147]
    ds_read_b128 v[80:83], v23 offset:0
    s_waitcnt lgkmcnt(9)
    v_mfma_f32_16x16x32_bf16 v[160:163], v[112:115], v[104:107], v[160:163]
    ds_read_b128 v[68:71], v18 offset:2048
    s_waitcnt lgkmcnt(9)
    v_mfma_f32_16x16x32_bf16 v[176:179], v[112:115], v[108:111], v[176:179]
    ds_read_b128 v[72:75], v18 offset:4096
    s_waitcnt lgkmcnt(8)
    v_mfma_f32_16x16x32_bf16 v[132:135], v[116:119], v[96:99], v[132:135]
    ds_read_b128 v[76:79], v18 offset:6144
    v_mfma_f32_16x16x32_bf16 v[148:151], v[116:119], v[100:103], v[148:151]
    ds_read_b128 v[84:87], v23 offset:2048
    v_mfma_f32_16x16x32_bf16 v[164:167], v[116:119], v[104:107], v[164:167]
    ds_read_b128 v[88:91], v23 offset:4096
    v_mfma_f32_16x16x32_bf16 v[180:183], v[116:119], v[108:111], v[180:183]
    ds_read_b128 v[92:95], v23 offset:6144
    s_waitcnt lgkmcnt(10)
    v_mfma_f32_16x16x32_bf16 v[136:139], v[120:123], v[96:99], v[136:139]
    s_mov_b32 s66, s67
    v_mov_b32 v11, v18
    v_mfma_f32_16x16x32_bf16 v[152:155], v[120:123], v[100:103], v[152:155]
    v_mov_b32 v16, v23
    v_mov_b32 v17, v24
    v_mfma_f32_16x16x32_bf16 v[168:171], v[120:123], v[104:107], v[168:171]
    v_mfma_f32_16x16x32_bf16 v[184:187], v[120:123], v[108:111], v[184:187]
    s_waitcnt lgkmcnt(8)
    v_mfma_f32_16x16x32_bf16 v[140:143], v[124:127], v[96:99], v[140:143]
    v_mfma_f32_16x16x32_bf16 v[156:159], v[124:127], v[100:103], v[156:159]
    v_mfma_f32_16x16x32_bf16 v[172:175], v[124:127], v[104:107], v[172:175]
    v_mfma_f32_16x16x32_bf16 v[188:191], v[124:127], v[108:111], v[188:191]
    s_barrier
    s_mov_b32 s65, 14
L_k2_kernel_ll:
    s_waitcnt lgkmcnt(6)
    v_mfma_f32_16x16x32_bf16 v[128:131], v[80:83], v[64:67], v[128:131]
    ds_read_b128 v[96:99], v11 offset:1024
    s_waitcnt lgkmcnt(6)
    v_mfma_f32_16x16x32_bf16 v[144:147], v[80:83], v[68:71], v[144:147]
    ds_read_b128 v[112:115], v17 offset:0
    s_waitcnt lgkmcnt(6)
    v_mfma_f32_16x16x32_bf16 v[160:163], v[80:83], v[72:75], v[160:163]
    ds_read_b128 v[100:103], v11 offset:3072
    s_waitcnt lgkmcnt(6)
    v_mfma_f32_16x16x32_bf16 v[176:179], v[80:83], v[76:79], v[176:179]
    ds_read_b128 v[104:107], v11 offset:5120
    s_waitcnt lgkmcnt(6)
    v_mfma_f32_16x16x32_bf16 v[132:135], v[84:87], v[64:67], v[132:135]
    ds_read_b128 v[108:111], v11 offset:7168
    v_mfma_f32_16x16x32_bf16 v[148:151], v[84:87], v[68:71], v[148:151]
    ds_read_b128 v[116:119], v17 offset:2048
    v_mfma_f32_16x16x32_bf16 v[164:167], v[84:87], v[72:75], v[164:167]
    ds_read_b128 v[120:123], v17 offset:4096
    v_mfma_f32_16x16x32_bf16 v[180:183], v[84:87], v[76:79], v[180:183]
    ds_read_b128 v[124:127], v17 offset:6144
    s_waitcnt lgkmcnt(9)
    v_mfma_f32_16x16x32_bf16 v[136:139], v[88:91], v[64:67], v[136:139]
    s_add_u32 s67, s66, 32768
    s_cmp_eq_u32 s67, 163840
    v_mfma_f32_16x16x32_bf16 v[152:155], v[88:91], v[68:71], v[152:155]
    s_cselect_b32 s67, 0, s67
    v_add_u32 v18, s67, v4
    v_mfma_f32_16x16x32_bf16 v[168:171], v[88:91], v[72:75], v[168:171]
    v_add_u32 v23, s67, v9
    v_add_u32 v24, s67, v10
    v_mfma_f32_16x16x32_bf16 v[184:187], v[88:91], v[76:79], v[184:187]
    s_waitcnt lgkmcnt(8)
    v_mfma_f32_16x16x32_bf16 v[140:143], v[92:95], v[64:67], v[140:143]
    v_mfma_f32_16x16x32_bf16 v[156:159], v[92:95], v[68:71], v[156:159]
    v_mfma_f32_16x16x32_bf16 v[172:175], v[92:95], v[72:75], v[172:175]
    v_mfma_f32_16x16x32_bf16 v[188:191], v[92:95], v[76:79], v[188:191]
    s_waitcnt lgkmcnt(6)
    v_mfma_f32_16x16x32_bf16 v[128:131], v[112:115], v[96:99], v[128:131]
    ds_read_b128 v[64:67], v18 offset:0
    s_waitcnt lgkmcnt(6)
    v_mfma_f32_16x16x32_bf16 v[144:147], v[112:115], v[100:103], v[144:147]
    ds_read_b128 v[80:83], v23 offset:0
    s_waitcnt lgkmcnt(6)
    v_mfma_f32_16x16x32_bf16 v[160:163], v[112:115], v[104:107], v[160:163]
    ds_read_b128 v[68:71], v18 offset:2048
    s_waitcnt lgkmcnt(6)
    v_mfma_f32_16x16x32_bf16 v[176:179], v[112:115], v[108:111], v[176:179]
    ds_read_b128 v[72:75], v18 offset:4096
    s_waitcnt lgkmcnt(6)
    v_mfma_f32_16x16x32_bf16 v[132:135], v[116:119], v[96:99], v[132:135]
    ds_read_b128 v[76:79], v18 offset:6144
    v_mfma_f32_16x16x32_bf16 v[148:151], v[116:119], v[100:103], v[148:151]
    ds_read_b128 v[84:87], v23 offset:2048
    v_mfma_f32_16x16x32_bf16 v[164:167], v[116:119], v[104:107], v[164:167]
    ds_read_b128 v[88:91], v23 offset:4096
    v_mfma_f32_16x16x32_bf16 v[180:183], v[116:119], v[108:111], v[180:183]
    ds_read_b128 v[92:95], v23 offset:6144
    s_waitcnt lgkmcnt(9)
    v_mfma_f32_16x16x32_bf16 v[136:139], v[120:123], v[96:99], v[136:139]
    s_mov_b32 s66, s67
    v_mov_b32 v11, v18
    v_mfma_f32_16x16x32_bf16 v[152:155], v[120:123], v[100:103], v[152:155]
    v_mov_b32 v16, v23
    v_mov_b32 v17, v24
    v_mfma_f32_16x16x32_bf16 v[168:171], v[120:123], v[104:107], v[168:171]
    v_mfma_f32_16x16x32_bf16 v[184:187], v[120:123], v[108:111], v[184:187]
    s_waitcnt lgkmcnt(8)
    v_mfma_f32_16x16x32_bf16 v[140:143], v[124:127], v[96:99], v[140:143]
    v_mfma_f32_16x16x32_bf16 v[156:159], v[124:127], v[100:103], v[156:159]
    v_mfma_f32_16x16x32_bf16 v[172:175], v[124:127], v[104:107], v[172:175]
    v_mfma_f32_16x16x32_bf16 v[188:191], v[124:127], v[108:111], v[188:191]
    s_barrier
    s_sub_u32 s65, s65, 1
    s_cmp_lg_u32 s65, 0
    s_cbranch_scc1 L_k2_kernel_ll
    s_waitcnt lgkmcnt(6)
    v_mfma_f32_16x16x32_bf16 v[128:131], v[80:83], v[64:67], v[128:131]
    ds_read_b128 v[96:99], v11 offset:1024
    s_waitcnt lgkmcnt(6)
    v_mfma_f32_16x16x32_bf16 v[144:147], v[80:83], v[68:71], v[144:147]
    ds_read_b128 v[112:115], v17 offset:0
    s_waitcnt lgkmcnt(6)
    v_mfma_f32_16x16x32_bf16 v[160:163], v[80:83], v[72:75], v[160:163]
    ds_read_b128 v[100:103], v11 offset:3072
    s_waitcnt lgkmcnt(6)
    v_mfma_f32_16x16x32_bf16 v[176:179], v[80:83], v[76:79], v[176:179]
    ds_read_b128 v[104:107], v11 offset:5120
    s_waitcnt lgkmcnt(6)
    v_mfma_f32_16x16x32_bf16 v[132:135], v[84:87], v[64:67], v[132:135]
    ds_read_b128 v[108:111], v11 offset:7168
    v_mfma_f32_16x16x32_bf16 v[148:151], v[84:87], v[68:71], v[148:151]
    ds_read_b128 v[116:119], v17 offset:2048
    v_mfma_f32_16x16x32_bf16 v[164:167], v[84:87], v[72:75], v[164:167]
    ds_read_b128 v[120:123], v17 offset:4096
    v_mfma_f32_16x16x32_bf16 v[180:183], v[84:87], v[76:79], v[180:183]
    ds_read_b128 v[124:127], v17 offset:6144
    s_waitcnt lgkmcnt(9)
    v_mfma_f32_16x16x32_bf16 v[136:139], v[88:91], v[64:67], v[136:139]
    s_add_u32 s67, s66, 32768
    s_cmp_eq_u32 s67, 163840
    v_mfma_f32_16x16x32_bf16 v[152:155], v[88:91], v[68:71], v[152:155]
    s_cselect_b32 s67, 0, s67
    v_add_u32 v18, s67, v4
    v_mfma_f32_16x16x32_bf16 v[168:171], v[88:91], v[72:75], v[168:171]
    v_add_u32 v23, s67, v9
    v_add_u32 v24, s67, v10
    v_mfma_f32_16x16x32_bf16 v[184:187], v[88:91], v[76:79], v[184:187]
    s_waitcnt lgkmcnt(8)
    v_mfma_f32_16x16x32_bf16 v[140:143], v[92:95], v[64:67], v[140:143]
    v_mfma_f32_16x16x32_bf16 v[156:159], v[92:95], v[68:71], v[156:159]
    v_mfma_f32_16x16x32_bf16 v[172:175], v[92:95], v[72:75], v[172:175]
    v_mfma_f32_16x16x32_bf16 v[188:191], v[92:95], v[76:79], v[188:191]
    s_waitcnt lgkmcnt(6)
    v_mfma_f32_16x16x32_bf16 v[128:131], v[112:115], v[96:99], v[128:131]
    ds_read_b128 v[64:67], v18 offset:0
    s_waitcnt lgkmcnt(6)
    v_mfma_f32_16x16x32_bf16 v[144:147], v[112:115], v[100:103], v[144:147]
    ds_read_b128 v[80:83], v23 offset:0
    s_waitcnt lgkmcnt(6)
    v_mfma_f32_16x16x32_bf16 v[160:163], v[112:115], v[104:107], v[160:163]
    ds_read_b128 v[68:71], v18 offset:2048
    s_waitcnt lgkmcnt(6)
    v_mfma_f32_16x16x32_bf16 v[176:179], v[112:115], v[108:111], v[176:179]
    ds_read_b128 v[72:75], v18 offset:4096
    s_waitcnt lgkmcnt(6)
    v_mfma_f32_16x16x32_bf16 v[132:135], v[116:119], v[96:99], v[132:135]
    ds_read_b128 v[76:79], v18 offset:6144
    v_mfma_f32_16x16x32_bf16 v[148:151], v[116:119], v[100:103], v[148:151]
    ds_read_b128 v[84:87], v23 offset:2048
    v_mfma_f32_16x16x32_bf16 v[164:167], v[116:119], v[104:107], v[164:167]
    ds_read_b128 v[88:91], v23 offset:4096
    v_mfma_f32_16x16x32_bf16 v[180:183], v[116:119], v[108:111], v[180:183]
    ds_read_b128 v[92:95], v23 offset:6144
    s_waitcnt lgkmcnt(9)
    v_mfma_f32_16x16x32_bf16 v[136:139], v[120:123], v[96:99], v[136:139]
    s_mov_b32 s66, s67
    v_mov_b32 v11, v18
    v_mfma_f32_16x16x32_bf16 v[152:155], v[120:123], v[100:103], v[152:155]
    v_mov_b32 v16, v23
    v_mov_b32 v17, v24
    v_mfma_f32_16x16x32_bf16 v[168:171], v[120:123], v[104:107], v[168:171]
    v_mfma_f32_16x16x32_bf16 v[184:187], v[120:123], v[108:111], v[184:187]
    s_waitcnt lgkmcnt(8)
    v_mfma_f32_16x16x32_bf16 v[140:143], v[124:127], v[96:99], v[140:143]
    v_mfma_f32_16x16x32_bf16 v[156:159], v[124:127], v[100:103], v[156:159]
    v_mfma_f32_16x16x32_bf16 v[172:175], v[124:127], v[104:107], v[172:175]
    v_mfma_f32_16x16x32_bf16 v[188:191], v[124:127], v[108:111], v[188:191]
    s_waitcnt lgkmcnt(6)
    v_mfma_f32_16x16x32_bf16 v[128:131], v[80:83], v[64:67], v[128:131]
    ds_read_b128 v[96:99], v11 offset:1024
    s_waitcnt lgkmcnt(6)
    v_mfma_f32_16x16x32_bf16 v[144:147], v[80:83], v[68:71], v[144:147]
    ds_read_b128 v[112:115], v17 offset:0
    s_waitcnt lgkmcnt(6)
    v_mfma_f32_16x16x32_bf16 v[160:163], v[80:83], v[72:75], v[160:163]
    ds_read_b128 v[100:103], v11 offset:3072
    s_waitcnt lgkmcnt(6)
    v_mfma_f32_16x16x32_bf16 v[176:179], v[80:83], v[76:79], v[176:179]
    ds_read_b128 v[104:107], v11 offset:5120
    s_waitcnt lgkmcnt(6)
    v_mfma_f32_16x16x32_bf16 v[132:135], v[84:87], v[64:67], v[132:135]
    ds_read_b128 v[108:111], v11 offset:7168
    v_mfma_f32_16x16x32_bf16 v[148:151], v[84:87], v[68:71], v[148:151]
    ds_read_b128 v[116:119], v17 offset:2048
    v_mfma_f32_16x16x32_bf16 v[164:167], v[84:87], v[72:75], v[164:167]
    ds_read_b128 v[120:123], v17 offset:4096
    v_mfma_f32_16x16x32_bf16 v[180:183], v[84:87], v[76:79], v[180:183]
    ds_read_b128 v[124:127], v17 offset:6144
    s_waitcnt lgkmcnt(9)
    v_mfma_f32_16x16x32_bf16 v[136:139], v[88:91], v[64:67], v[136:139]
    v_mfma_f32_16x16x32_bf16 v[152:155], v[88:91], v[68:71], v[152:155]
    v_mfma_f32_16x16x32_bf16 v[168:171], v[88:91], v[72:75], v[168:171]
    v_mfma_f32_16x16x32_bf16 v[184:187], v[88:91], v[76:79], v[184:187]
    s_waitcnt lgkmcnt(8)
    v_mfma_f32_16x16x32_bf16 v[140:143], v[92:95], v[64:67], v[140:143]
    v_mfma_f32_16x16x32_bf16 v[156:159], v[92:95], v[68:71], v[156:159]
    v_mfma_f32_16x16x32_bf16 v[172:175], v[92:95], v[72:75], v[172:175]
    v_mfma_f32_16x16x32_bf16 v[188:191], v[92:95], v[76:79], v[188:191]
    s_waitcnt lgkmcnt(6)
    v_mfma_f32_16x16x32_bf16 v[128:131], v[112:115], v[96:99], v[128:131]
    s_waitcnt lgkmcnt(5)
    v_mfma_f32_16x16x32_bf16 v[144:147], v[112:115], v[100:103], v[144:147]
    s_waitcnt lgkmcnt(4)
    v_mfma_f32_16x16x32_bf16 v[160:163], v[112:115], v[104:107], v[160:163]
    s_waitcnt lgkmcnt(3)
    v_mfma_f32_16x16x32_bf16 v[176:179], v[112:115], v[108:111], v[176:179]
    s_waitcnt lgkmcnt(2)
    v_mfma_f32_16x16x32_bf16 v[132:135], v[116:119], v[96:99], v[132:135]
    v_mfma_f32_16x16x32_bf16 v[148:151], v[116:119], v[100:103], v[148:151]
    v_mfma_f32_16x16x32_bf16 v[164:167], v[116:119], v[104:107], v[164:167]
    v_mfma_f32_16x16x32_bf16 v[180:183], v[116:119], v[108:111], v[180:183]
    s_waitcnt lgkmcnt(1)
    v_mfma_f32_16x16x32_bf16 v[136:139], v[120:123], v[96:99], v[136:139]
    v_mfma_f32_16x16x32_bf16 v[152:155], v[120:123], v[100:103], v[152:155]
    v_mfma_f32_16x16x32_bf16 v[168:171], v[120:123], v[104:107], v[168:171]
    v_mfma_f32_16x16x32_bf16 v[184:187], v[120:123], v[108:111], v[184:187]
    s_waitcnt lgkmcnt(0)
    v_mfma_f32_16x16x32_bf16 v[140:143], v[124:127], v[96:99], v[140:143]
    v_mfma_f32_16x16x32_bf16 v[156:159], v[124:127], v[100:103], v[156:159]
    v_mfma_f32_16x16x32_bf16 v[172:175], v[124:127], v[104:107], v[172:175]
    v_mfma_f32_16x16x32_bf16 v[188:191], v[124:127], v[108:111], v[188:191]
L_k2_kernel_epi:
    s_barrier
    ds_read_b32 v224, v237 offset:0
    ds_read_b32 v225, v237 offset:256
    ds_read_b64 v[208:209], v238 offset:0
    ds_read_b64 v[216:217], v238 offset:256
    ds_read_b64 v[192:193], v233 offset:0
    ds_read_b64 v[200:201], v233 offset:4096
    ds_read_b64 v[210:211], v238 offset:32
    ds_read_b64 v[218:219], v238 offset:288
    ds_read_b64 v[194:195], v234 offset:0
    ds_read_b64 v[202:203], v234 offset:4096
    ds_read_b64 v[212:213], v238 offset:64
    ds_read_b64 v[220:221], v238 offset:320
    ds_read_b64 v[196:197], v235 offset:0
    ds_read_b64 v[204:205], v235 offset:4096
    ds_read_b64 v[214:215], v238 offset:96
    ds_read_b64 v[222:223], v238 offset:352
    ds_read_b64 v[198:199], v236 offset:0
    ds_read_b64 v[206:207], v236 offset:4096
    s_lshl_b32 s68, s76, 1
    s_add_u32 s69, s68, s61
    s_lshl_b32 s69, s69, 14
    s_lshl_b32 s70, s60, 12
    s_add_u32 s69, s69, s70
    s_xor_b32 s65, s61, 1
    s_add_u32 s68, s68, s65
    s_lshl_b32 s68, s68, 14
    s_add_u32 s68, s68, s70
    v_lshlrev_b32 v2, 4, v1
    s_nop 7
    s_cmp_eq_u32 s61, 0
    s_cbranch_scc0 L_k2_kernel_send1
    v_cvt_pk_f16_f32 v96, v160, v161
    v_cvt_pk_f16_f32 v97, v162, v163
    v_cvt_pk_f16_f32 v98, v164, v165
    v_cvt_pk_f16_f32 v99, v166, v167
    buffer_store_dwordx4 v[96:99], v2, s[44:47], s69 offen offset:0 sc0 sc1
    v_cvt_pk_f16_f32 v100, v168, v169
    v_cvt_pk_f16_f32 v101, v170, v171
    v_cvt_pk_f16_f32 v102, v172, v173
    v_cvt_pk_f16_f32 v103, v174, v175
    buffer_store_dwordx4 v[100:103], v2, s[44:47], s69 offen offset:1024 sc0 sc1
    v_cvt_pk_f16_f32 v104, v176, v177
    v_cvt_pk_f16_f32 v105, v178, v179
    v_cvt_pk_f16_f32 v106, v180, v181
    v_cvt_pk_f16_f32 v107, v182, v183
    buffer_store_dwordx4 v[104:107], v2, s[44:47], s69 offen offset:2048 sc0 sc1
    v_cvt_pk_f16_f32 v108, v184, v185
    v_cvt_pk_f16_f32 v109, v186, v187
    v_cvt_pk_f16_f32 v110, v188, v189
    v_cvt_pk_f16_f32 v111, v190, v191
    buffer_store_dwordx4 v[108:111], v2, s[44:47], s69 offen offset:3072 sc0 sc1
    s_branch L_k2_kernel_sent
L_k2_kernel_send1:
    v_cvt_pk_f16_f32 v96, v128, v129
    v_cvt_pk_f16_f32 v97, v130, v131
    v_cvt_pk_f16_f32 v98, v132, v133
    v_cvt_pk_f16_f32 v99, v134, v135
    buffer_store_dwordx4 v[96:99], v2, s[44:47], s69 offen offset:0 sc0 sc1
    v_cvt_pk_f16_f32 v100, v136, v137
    v_cvt_pk_f16_f32 v101, v138, v139
    v_cvt_pk_f16_f32 v102, v140, v141
    v_cvt_pk_f16_f32 v103, v142, v143
    buffer_store_dwordx4 v[100:103], v2, s[44:47], s69 offen offset:1024 sc0 sc1
    v_cvt_pk_f16_f32 v104, v144, v145
    v_cvt_pk_f16_f32 v105, v146, v147
    v_cvt_pk_f16_f32 v106, v148, v149
    v_cvt_pk_f16_f32 v107, v150, v151
    buffer_store_dwordx4 v[104:107], v2, s[44:47], s69 offen offset:2048 sc0 sc1
    v_cvt_pk_f16_f32 v108, v152, v153
    v_cvt_pk_f16_f32 v109, v154, v155
    v_cvt_pk_f16_f32 v110, v156, v157
    v_cvt_pk_f16_f32 v111, v158, v159
    buffer_store_dwordx4 v[108:111], v2, s[44:47], s69 offen offset:3072 sc0 sc1
    v_mov_b32 v128, v160
    v_mov_b32 v129, v161
    v_mov_b32 v130, v162
    v_mov_b32 v131, v163
    v_mov_b32 v132, v164
    v_mov_b32 v133, v165
    v_mov_b32 v134, v166
    v_mov_b32 v135, v167
    v_mov_b32 v136, v168
    v_mov_b32 v137, v169
    v_mov_b32 v138, v170
    v_mov_b32 v139, v171
    v_mov_b32 v140, v172
    v_mov_b32 v141, v173
    v_mov_b32 v142, v174
    v_mov_b32 v143, v175
    v_mov_b32 v144, v176
    v_mov_b32 v145, v177
    v_mov_b32 v146, v178
    v_mov_b32 v147, v179
    v_mov_b32 v148, v180
    v_mov_b32 v149, v181
    v_mov_b32 v150, v182
    v_mov_b32 v151, v183
    v_mov_b32 v152, v184
    v_mov_b32 v153, v185
    v_mov_b32 v154, v186
    v_mov_b32 v155, v187
    v_mov_b32 v156, v188
    v_mov_b32 v157, v189
    v_mov_b32 v158, v190
    v_mov_b32 v159, v191
L_k2_kernel_sent:
    s_waitcnt lgkmcnt(0)
    v_sub_f32 v64, 1.0, v224
    v_cvt_pk_bf16_f32 v64, v64, v64
    v_lshlrev_b32 v65, 16, v64
    v_sub_f32 v64, 1.0, v225
    v_cvt_pk_bf16_f32 v64, v64, v64
    v_lshlrev_b32 v66, 16, v64
    v_lshlrev_b32 v68, 16, v208
    v_and_b32 v69, 0xffff0000, v208
    v_lshlrev_b32 v72, 16, v216
    v_and_b32 v73, 0xffff0000, v216
    v_lshlrev_b32 v70, 16, v209
    v_and_b32 v71, 0xffff0000, v209
    v_lshlrev_b32 v74, 16, v217
    v_and_b32 v75, 0xffff0000, v217
    v_lshlrev_b32 v76, 16, v192
    v_and_b32 v77, 0xffff0000, v192
    v_lshlrev_b32 v78, 16, v193
    v_and_b32 v79, 0xffff0000, v193
    v_mul_f32 v76, v76, v68
    v_mul_f32 v77, v77, v69
    v_mul_f32 v78, v78, v70
    v_mul_f32 v79, v79, v71
    v_cvt_pk_bf16_f32 v80, v76, v77
    v_cvt_pk_bf16_f32 v81, v78, v79
    v_lshlrev_b32 v76, 16, v80
    v_and_b32 v77, 0xffff0000, v80
    v_lshlrev_b32 v78, 16, v81
    v_and_b32 v79, 0xffff0000, v81
    v_fmac_f32 v128, v224, v76
    v_fmac_f32 v128, v65, v72
    v_fmac_f32 v129, v224, v77
    v_fmac_f32 v129, v65, v73
    v_fmac_f32 v130, v224, v78
    v_fmac_f32 v130, v65, v74
    v_fmac_f32 v131, v224, v79
    v_fmac_f32 v131, v65, v75
    v_lshlrev_b32 v76, 16, v200
    v_and_b32 v77, 0xffff0000, v200
    v_lshlrev_b32 v78, 16, v201
    v_and_b32 v79, 0xffff0000, v201
    v_mul_f32 v76, v76, v68
    v_mul_f32 v77, v77, v69
    v_mul_f32 v78, v78, v70
    v_mul_f32 v79, v79, v71
    v_cvt_pk_bf16_f32 v80, v76, v77
    v_cvt_pk_bf16_f32 v81, v78, v79
    v_lshlrev_b32 v76, 16, v80
    v_and_b32 v77, 0xffff0000, v80
    v_lshlrev_b32 v78, 16, v81
    v_and_b32 v79, 0xffff0000, v81
    v_fmac_f32 v144, v225, v76
    v_fmac_f32 v144, v66, v72
    v_fmac_f32 v145, v225, v77
    v_fmac_f32 v145, v66, v73
    v_fmac_f32 v146, v225, v78
    v_fmac_f32 v146, v66, v74
    v_fmac_f32 v147, v225, v79
    v_fmac_f32 v147, v66, v75
    v_lshlrev_b32 v68, 16, v210
    v_and_b32 v69, 0xffff0000, v210
    v_lshlrev_b32 v72, 16, v218
    v_and_b32 v73, 0xffff0000, v218
    v_lshlrev_b32 v70, 16, v211
    v_and_b32 v71, 0xffff0000, v211
    v_lshlrev_b32 v74, 16, v219
    v_and_b32 v75, 0xffff0000, v219
    v_lshlrev_b32 v76, 16, v194
    v_and_b32 v77, 0xffff0000, v194
    v_lshlrev_b32 v78, 16, v195
    v_and_b32 v79, 0xffff0000, v195
    v_mul_f32 v76, v76, v68
    v_mul_f32 v77, v77, v69
    v_mul_f32 v78, v78, v70
    v_mul_f32 v79, v79, v71
    v_cvt_pk_bf16_f32 v80, v76, v77
    v_cvt_pk_bf16_f32 v81, v78, v79
    v_lshlrev_b32 v76, 16, v80
    v_and_b32 v77, 0xffff0000, v80
    v_lshlrev_b32 v78, 16, v81
    v_and_b32 v79, 0xffff0000, v81
    v_fmac_f32 v132, v224, v76
    v_fmac_f32 v132, v65, v72
    v_fmac_f32 v133, v224, v77
    v_fmac_f32 v133, v65, v73
    v_fmac_f32 v134, v224, v78
    v_fmac_f32 v134, v65, v74
    v_fmac_f32 v135, v224, v79
    v_fmac_f32 v135, v65, v75
    v_lshlrev_b32 v76, 16, v202
    v_and_b32 v77, 0xffff0000, v202
    v_lshlrev_b32 v78, 16, v203
    v_and_b32 v79, 0xffff0000, v203
    v_mul_f32 v76, v76, v68
    v_mul_f32 v77, v77, v69
    v_mul_f32 v78, v78, v70
    v_mul_f32 v79, v79, v71
    v_cvt_pk_bf16_f32 v80, v76, v77
    v_cvt_pk_bf16_f32 v81, v78, v79
    v_lshlrev_b32 v76, 16, v80
    v_and_b32 v77, 0xffff0000, v80
    v_lshlrev_b32 v78, 16, v81
    v_and_b32 v79, 0xffff0000, v81
    v_fmac_f32 v148, v225, v76
    v_fmac_f32 v148, v66, v72
    v_fmac_f32 v149, v225, v77
    v_fmac_f32 v149, v66, v73
    v_fmac_f32 v150, v225, v78
    v_fmac_f32 v150, v66, v74
    v_fmac_f32 v151, v225, v79
    v_fmac_f32 v151, v66, v75
    v_lshlrev_b32 v68, 16, v212
    v_and_b32 v69, 0xffff0000, v212
    v_lshlrev_b32 v72, 16, v220
    v_and_b32 v73, 0xffff0000, v220
    v_lshlrev_b32 v70, 16, v213
    v_and_b32 v71, 0xffff0000, v213
    v_lshlrev_b32 v74, 16, v221
    v_and_b32 v75, 0xffff0000, v221
    v_lshlrev_b32 v76, 16, v196
    v_and_b32 v77, 0xffff0000, v196
    v_lshlrev_b32 v78, 16, v197
    v_and_b32 v79, 0xffff0000, v197
    v_mul_f32 v76, v76, v68
    v_mul_f32 v77, v77, v69
    v_mul_f32 v78, v78, v70
    v_mul_f32 v79, v79, v71
    v_cvt_pk_bf16_f32 v80, v76, v77
    v_cvt_pk_bf16_f32 v81, v78, v79
    v_lshlrev_b32 v76, 16, v80
    v_and_b32 v77, 0xffff0000, v80
    v_lshlrev_b32 v78, 16, v81
    v_and_b32 v79, 0xffff0000, v81
    v_fmac_f32 v136, v224, v76
    v_fmac_f32 v136, v65, v72
    v_fmac_f32 v137, v224, v77
    v_fmac_f32 v137, v65, v73
    v_fmac_f32 v138, v224, v78
    v_fmac_f32 v138, v65, v74
    v_fmac_f32 v139, v224, v79
    v_fmac_f32 v139, v65, v75
    v_lshlrev_b32 v76, 16, v204
    v_and_b32 v77, 0xffff0000, v204
    v_lshlrev_b32 v78, 16, v205
    v_and_b32 v79, 0xffff0000, v205
    v_mul_f32 v76, v76, v68
    v_mul_f32 v77, v77, v69
    v_mul_f32 v78, v78, v70
    v_mul_f32 v79, v79, v71
    v_cvt_pk_bf16_f32 v80, v76, v77
    v_cvt_pk_bf16_f32 v81, v78, v79
    v_lshlrev_b32 v76, 16, v80
    v_and_b32 v77, 0xffff0000, v80
    v_lshlrev_b32 v78, 16, v81
    v_and_b32 v79, 0xffff0000, v81
    v_fmac_f32 v152, v225, v76
    v_fmac_f32 v152, v66, v72
    v_fmac_f32 v153, v225, v77
    v_fmac_f32 v153, v66, v73
    v_fmac_f32 v154, v225, v78
    v_fmac_f32 v154, v66, v74
    v_fmac_f32 v155, v225, v79
    v_fmac_f32 v155, v66, v75
    v_lshlrev_b32 v68, 16, v214
    v_and_b32 v69, 0xffff0000, v214
    v_lshlrev_b32 v72, 16, v222
    v_and_b32 v73, 0xffff0000, v222
    v_lshlrev_b32 v70, 16, v215
    v_and_b32 v71, 0xffff0000, v215
    v_lshlrev_b32 v74, 16, v223
    v_and_b32 v75, 0xffff0000, v223
    v_lshlrev_b32 v76, 16, v198
    v_and_b32 v77, 0xffff0000, v198
    v_lshlrev_b32 v78, 16, v199
    v_and_b32 v79, 0xffff0000, v199
    v_mul_f32 v76, v76, v68
    v_mul_f32 v77, v77, v69
    v_mul_f32 v78, v78, v70
    v_mul_f32 v79, v79, v71
    v_cvt_pk_bf16_f32 v80, v76, v77
    v_cvt_pk_bf16_f32 v81, v78, v79
    v_lshlrev_b32 v76, 16, v80
    v_and_b32 v77, 0xffff0000, v80
    v_lshlrev_b32 v78, 16, v81
    v_and_b32 v79, 0xffff0000, v81
    v_fmac_f32 v140, v224, v76
    v_fmac_f32 v140, v65, v72
    v_fmac_f32 v141, v224, v77
    v_fmac_f32 v141, v65, v73
    v_fmac_f32 v142, v224, v78
    v_fmac_f32 v142, v65, v74
    v_fmac_f32 v143, v224, v79
    v_fmac_f32 v143, v65, v75
    v_lshlrev_b32 v76, 16, v206
    v_and_b32 v77, 0xffff0000, v206
    v_lshlrev_b32 v78, 16, v207
    v_and_b32 v79, 0xffff0000, v207
    v_mul_f32 v76, v76, v68
    v_mul_f32 v77, v77, v69
    v_mul_f32 v78, v78, v70
    v_mul_f32 v79, v79, v71
    v_cvt_pk_bf16_f32 v80, v76, v77
    v_cvt_pk_bf16_f32 v81, v78, v79
    v_lshlrev_b32 v76, 16, v80
    v_and_b32 v77, 0xffff0000, v80
    v_lshlrev_b32 v78, 16, v81
    v_and_b32 v79, 0xffff0000, v81
    v_fmac_f32 v156, v225, v76
    v_fmac_f32 v156, v66, v72
    v_fmac_f32 v157, v225, v77
    v_fmac_f32 v157, v66, v73
    v_fmac_f32 v158, v225, v78
    v_fmac_f32 v158, v66, v74
    v_fmac_f32 v159, v225, v79
    v_fmac_f32 v159, v66, v75
    s_mov_b32 s65, 20000
L_k2_kernel_rx:
    buffer_load_dwordx4 v[26:29], v2, s[44:47], s68 offen offset:0 sc0 sc1
    buffer_load_dwordx4 v[30:33], v2, s[44:47], s68 offen offset:1024 sc0 sc1
    buffer_load_dwordx4 v[34:37], v2, s[44:47], s68 offen offset:2048 sc0 sc1
    buffer_load_dwordx4 v[38:41], v2, s[44:47], s68 offen offset:3072 sc0 sc1
    s_waitcnt vmcnt(0)
    s_mov_b64 s[78:79], 0
    v_cmp_eq_u32 vcc, -1, v26
    s_or_b64 s[78:79], s[78:79], vcc
    v_cmp_eq_u32 vcc, -1, v27
    s_or_b64 s[78:79], s[78:79], vcc
    v_cmp_eq_u32 vcc, -1, v28
    s_or_b64 s[78:79], s[78:79], vcc
    v_cmp_eq_u32 vcc, -1, v29
    s_or_b64 s[78:79], s[78:79], vcc
    v_cmp_eq_u32 vcc, -1, v30
    s_or_b64 s[78:79], s[78:79], vcc
    v_cmp_eq_u32 vcc, -1, v31
    s_or_b64 s[78:79], s[78:79], vcc
    v_cmp_eq_u32 vcc, -1, v32
    s_or_b64 s[78:79], s[78:79], vcc
    v_cmp_eq_u32 vcc, -1, v33
    s_or_b64 s[78:79], s[78:79], vcc
    v_cmp_eq_u32 vcc, -1, v34
    s_or_b64 s[78:79], s[78:79], vcc
    v_cmp_eq_u32 vcc, -1, v35
    s_or_b64 s[78:79], s[78:79], vcc
    v_cmp_eq_u32 vcc, -1, v36
    s_or_b64 s[78:79], s[78:79], vcc
    v_cmp_eq_u32 vcc, -1, v37
    s_or_b64 s[78:79], s[78:79], vcc
    v_cmp_eq_u32 vcc, -1, v38
    s_or_b64 s[78:79], s[78:79], vcc
    v_cmp_eq_u32 vcc, -1, v39
    s_or_b64 s[78:79], s[78:79], vcc
    v_cmp_eq_u32 vcc, -1, v40
    s_or_b64 s[78:79], s[78:79], vcc
    v_cmp_eq_u32 vcc, -1, v41
    s_or_b64 s[78:79], s[78:79], vcc
    s_cmp_eq_u64 s[78:79], 0
    s_cbranch_scc1 L_k2_kernel_rxok
    s_sub_u32 s65, s65, 1
    s_cmp_lg_u32 s65, 0
    s_cbranch_scc1 L_k2_kernel_rx
L_k2_kernel_rxok:
    s_mov_b32 s70, 16384
    v_fma_mix_f32 v128, v26, 1.0, v128 op_sel:[0,0,0] op_sel_hi:[1,0,0]
    v_fma_mix_f32 v129, v26, 1.0, v129 op_sel:[1,0,0] op_sel_hi:[1,0,0]
    v_fma_mix_f32 v130, v27, 1.0, v130 op_sel:[0,0,0] op_sel_hi:[1,0,0]
    v_fma_mix_f32 v131, v27, 1.0, v131 op_sel:[1,0,0] op_sel_hi:[1,0,0]
    buffer_store_dwordx4 v[128:131], v227, s[40:43], 0 offen offset:0 sc0 sc1
    v_fma_mix_f32 v132, v28, 1.0, v132 op_sel:[0,0,0] op_sel_hi:[1,0,0]
    v_fma_mix_f32 v133, v28, 1.0, v133 op_sel:[1,0,0] op_sel_hi:[1,0,0]
    v_fma_mix_f32 v134, v29, 1.0, v134 op_sel:[0,0,0] op_sel_hi:[1,0,0]
    v_fma_mix_f32 v135, v29, 1.0, v135 op_sel:[1,0,0] op_sel_hi:[1,0,0]
    buffer_store_dwordx4 v[132:135], v227, s[40:43], 0 offen offset:64 sc0 sc1
    v_fma_mix_f32 v136, v30, 1.0, v136 op_sel:[0,0,0] op_sel_hi:[1,0,0]
    v_fma_mix_f32 v137, v30, 1.0, v137 op_sel:[1,0,0] op_sel_hi:[1,0,0]
    v_fma_mix_f32 v138, v31, 1.0, v138 op_sel:[0,0,0] op_sel_hi:[1,0,0]
    v_fma_mix_f32 v139, v31, 1.0, v139 op_sel:[1,0,0] op_sel_hi:[1,0,0]
    buffer_store_dwordx4 v[136:139], v227, s[40:43], 0 offen offset:128 sc0 sc1
    v_fma_mix_f32 v140, v32, 1.0, v140 op_sel:[0,0,0] op_sel_hi:[1,0,0]
    v_fma_mix_f32 v141, v32, 1.0, v141 op_sel:[1,0,0] op_sel_hi:[1,0,0]
    v_fma_mix_f32 v142, v33, 1.0, v142 op_sel:[0,0,0] op_sel_hi:[1,0,0]
    v_fma_mix_f32 v143, v33, 1.0, v143 op_sel:[1,0,0] op_sel_hi:[1,0,0]
    buffer_store_dwordx4 v[140:143], v227, s[40:43], 0 offen offset:192 sc0 sc1
    v_fma_mix_f32 v144, v34, 1.0, v144 op_sel:[0,0,0] op_sel_hi:[1,0,0]
    v_fma_mix_f32 v145, v34, 1.0, v145 op_sel:[1,0,0] op_sel_hi:[1,0,0]
    v_fma_mix_f32 v146, v35, 1.0, v146 op_sel:[0,0,0] op_sel_hi:[1,0,0]
    v_fma_mix_f32 v147, v35, 1.0, v147 op_sel:[1,0,0] op_sel_hi:[1,0,0]
    buffer_store_dwordx4 v[144:147], v227, s[40:43], s70 offen offset:0 sc0 sc1
    v_fma_mix_f32 v148, v36, 1.0, v148 op_sel:[0,0,0] op_sel_hi:[1,0,0]
    v_fma_mix_f32 v149, v36, 1.0, v149 op_sel:[1,0,0] op_sel_hi:[1,0,0]
    v_fma_mix_f32 v150, v37, 1.0, v150 op_sel:[0,0,0] op_sel_hi:[1,0,0]
    v_fma_mix_f32 v151, v37, 1.0, v151 op_sel:[1,0,0] op_sel_hi:[1,0,0]
    buffer_store_dwordx4 v[148:151], v227, s[40:43], s70 offen offset:64 sc0 sc1
    v_fma_mix_f32 v152, v38, 1.0, v152 op_sel:[0,0,0] op_sel_hi:[1,0,0]
    v_fma_mix_f32 v153, v38, 1.0, v153 op_sel:[1,0,0] op_sel_hi:[1,0,0]
    v_fma_mix_f32 v154, v39, 1.0, v154 op_sel:[0,0,0] op_sel_hi:[1,0,0]
    v_fma_mix_f32 v155, v39, 1.0, v155 op_sel:[1,0,0] op_sel_hi:[1,0,0]
    buffer_store_dwordx4 v[152:155], v227, s[40:43], s70 offen offset:128 sc0 sc1
    v_fma_mix_f32 v156, v40, 1.0, v156 op_sel:[0,0,0] op_sel_hi:[1,0,0]
    v_fma_mix_f32 v157, v40, 1.0, v157 op_sel:[1,0,0] op_sel_hi:[1,0,0]
    v_fma_mix_f32 v158, v41, 1.0, v158 op_sel:[0,0,0] op_sel_hi:[1,0,0]
    v_fma_mix_f32 v159, v41, 1.0, v159 op_sel:[1,0,0] op_sel_hi:[1,0,0]
    buffer_store_dwordx4 v[156:159], v227, s[40:43], s70 offen offset:192 sc0 sc1
L_k2_kernel_fin:
    s_branch L_k2_kernel_end
L_k2_kernel_end:
    s_endpgm
L_code_end:
.section .rodata,"a"
.p2align 6
.amdhsa_kernel k1_kernel
  .amdhsa_next_free_vgpr 256
  .amdhsa_next_free_sgpr 102
  .amdhsa_accum_offset 256
  .amdhsa_group_segment_fixed_size 0
  .amdhsa_kernarg_size 144
  .amdhsa_user_sgpr_count 2
  .amdhsa_user_sgpr_kernarg_segment_ptr 1
  .amdhsa_system_sgpr_workgroup_id_x 1
.end_amdhsa_kernel
```
